```python
import torch

def _softmax(x, axis=-1):
    return torch.softmax(x, dim=axis)
def _gelu(x):
    return torch.nn.functional.gelu(x, approximate="tanh")
def _silu(x):
    return torch.nn.functional.silu(x)
def _sigmoid(x):
    return torch.sigmoid(x)
def _layernorm(x, axis=-1, eps=1e-5):
    m = x.mean(dim=axis, keepdim=True)
    v = x.var(dim=axis, keepdim=True, unbiased=False)
    return (x - m) / torch.sqrt(v + eps)
def _scatter_add(tgt, idx, src, axis=0):
    return tgt.clone().index_add_(axis, idx, src)
def _segment_sum(src, seg, n):
    out = torch.zeros((n,) + src.shape[1:], dtype=src.dtype)
    return out.index_add_(0, seg, src)
def _pad(x, pw):
    flat = tuple(v for pair in reversed(pw) for v in pair)
    return torch.nn.functional.pad(x, flat)

kernel_name = 'sequential_preLN__ssm_conv_h3__glu_gated_glu__prompt'

def setup_inputs():

    _w = (lambda a: (lambda t: t.to(torch.bfloat16) if t.is_floating_point() else t)(torch.as_tensor(a)))
    def _A_setup():
        B, S, D = 1, 2048, 512
        ks = 4
        return {
            "q": _w((lambda *s: torch.randn(*s, dtype=torch.bfloat16) * 0.05)(B, S, D)),
            "k": _w((lambda *s: torch.randn(*s, dtype=torch.bfloat16) * 0.4)(B, S, D)),
            "v": _w((lambda *s: torch.randn(*s, dtype=torch.bfloat16) * 0.4)(B, S, D)),
            "shift_k": _w((lambda *s: torch.randn(*s, dtype=torch.bfloat16) * 0.4)(D, ks) * 0.5),
            "ssm_k": _w((lambda *s: torch.randn(*s, dtype=torch.bfloat16) * 0.4)(D, S) * (1.0 / S ** 0.5)),
            "ssm_D": _w((lambda *s: torch.randn(*s, dtype=torch.bfloat16) * 0.4)(D)),
        }
    _A_in = _A_setup()

    def _B_setup():
        B, S, D, F = 1, 2048, 512, 1376
        return {
            "x": _w((lambda *s: torch.randn(*s, dtype=torch.bfloat16) * 0.05)(B, S, D)),
            "w_gate": _w((lambda *s: torch.randn(*s, dtype=torch.bfloat16) * 0.05)(D, F)),
            "w_up": _w((lambda *s: torch.randn(*s, dtype=torch.bfloat16) * 0.05)(D, F)),
            "w_down": _w((lambda *s: torch.randn(*s, dtype=torch.bfloat16) * 0.05)(F, D)),
        }
    _B_in = _B_setup()

    return {
        "A_q": _A_in["q"],
        "A_k": _A_in["k"],
        "A_v": _A_in["v"],
        "A_shift_k": _A_in["shift_k"],
        "A_ssm_k": _A_in["ssm_k"],
        "A_ssm_D": _A_in["ssm_D"],
        "B_x": _B_in["x"],
        "B_w_gate": _B_in["w_gate"],
        "B_w_up": _B_in["w_up"],
        "B_w_down": _B_in["w_down"],
    }

def reference(A_q, A_k, A_v, A_shift_k, A_ssm_k, A_ssm_D, B_x, B_w_gate, B_w_up, B_w_down):
    def _A_ref(q, k, v, shift_k, ssm_k, ssm_D):
        B, S, D = q.shape
        ks = shift_k.shape[-1]
        k_pad = _pad(k, ((0, 0), (ks - 1, 0), (0, 0)))
        k_shift = torch.zeros_like(k)
        for t in range(ks):
            k_shift = k_shift + k_pad[:, t:t + S, :] * shift_k[:, ks - 1 - t][None, None, :]
        kv = k_shift * v
        L = 2 * S
        kv_pad = _pad(kv, ((0, 0), (0, S), (0, 0)))
        kf_pad = _pad(ssm_k, ((0, 0), (0, S)))
        kv_f = (lambda x, axes=(-2,-1): torch.fft.rfft2(x.float(), dim=axes))(kv_pad[:, None, :, :], axes=(1, 2))
        kf_f = (lambda x, axes=(-2,-1): torch.fft.rfft2(x.float(), dim=axes))(kf_pad[:, None, :], axes=(1, 2))
        kf_f = (lambda x, *d: x.permute(*d))(kf_f, 1, 2, 0)
        y_f = kv_f * kf_f[None, :, :, :]
        y = (lambda x, s, axes=(-2,-1): torch.fft.irfft2(x, s=s, dim=axes).to(torch.bfloat16))(y_f, (1, L), axes=(1, 2))[:, 0, :S, :]
        y = y + kv * ssm_D[None, None, :]
        return q * y

    def _B_ref(x, w_gate, w_up, w_down):
        g = torch.einsum("bsd,df->bsf", x, w_gate)
        u = torch.einsum("bsd,df->bsf", x, w_up)
        h = _sigmoid(g) * u
        return torch.einsum("bsf,fd->bsd", h, w_down)

    x = A_q
    h = x + _A_ref(_layernorm(x, axis=-1), A_k, A_v, A_shift_k, A_ssm_k, A_ssm_D)
    h2 = h + _B_ref(_layernorm(h, axis=-1), B_w_gate, B_w_up, B_w_down)
    return h2
```

```asm
; @launch grid=(256,1,1) block=(256,1,1) lds=163840
.amdgcn_target "amdgcn-amd-amdhsa--gfx950"
.text
.set CODE_LAST, (L_code_end - L_pc - 4) & ~3
.globl sequential_preLN__ssm_conv_h3__glu_gated_glu__prompt_kernel
.p2align 8
.type sequential_preLN__ssm_conv_h3__glu_gated_glu__prompt_kernel,@function
sequential_preLN__ssm_conv_h3__glu_gated_glu__prompt_kernel:
    s_cmp_ge_u32 s2, 256
    s_cbranch_scc1 L_end
    s_getpc_b64 s[52:53]
L_pc:
    s_load_dwordx4 s[12:15], s[0:1], 8
    s_load_dwordx2 s[8:9], s[0:1], 0
    v_lshlrev_b32 v9, 7, v0
    v_cmp_gt_u32 vcc, 32, v0
    s_and_saveexec_b64 s[66:67], vcc
    s_cbranch_execz L_nopf
    global_load_dword v158, v9, s[52:53] offset:128
L_nopf:
    s_mov_b64 exec, -1
    s_load_dwordx4 s[40:43], s[0:1], 24
    s_load_dwordx2 s[36:37], s[0:1], 96
    s_load_dwordx2 s[50:51], s[0:1], 40
    s_load_dwordx4 s[24:27], s[0:1], 56
    s_load_dwordx4 s[28:31], s[0:1], 72
    v_and_b32 v1, 63, v0
    v_lshrrev_b32 v2, 6, v0
    s_and_b32 s4, s2, 7
    s_lshr_b32 s5, s2, 3
    v_readfirstlane_b32 s3, v2
    s_mov_b32 s19, 0x20000
    s_mov_b32 s18, 2097152
    s_mov_b32 s10, s18
    s_mov_b32 s11, s19
    s_movk_i32 s54, 8192
    v_and_b32 v2, 7, v1
    v_lshrrev_b32 v3, 3, v1
    s_lshl_b32 s60, s5, 16
    s_lshl_b32 s61, s4, 7
    s_add_u32 s60, s60, s61
    v_lshlrev_b32 v4, 10, v3
    v_lshl_add_u32 v4, v2, 4, v4
    v_add_u32 v5, s60, v4
    s_lshl_b32 s61, s3, 14
    v_add_u32 v4, s61, v5
    s_mul_i32 s62, s3, 2112
    s_waitcnt lgkmcnt(0)
    s_mov_b32 s16, s14
    s_mov_b32 s17, s15
    s_mov_b32 s14, s18
    s_mov_b32 s15, s19
    s_add_u32 m0, s62, 18048
    s_nop 0
    buffer_load_dwordx4 v4, s[8:11], 0 offen nt lds
    s_add_u32 m0, s62, 19104
    s_nop 0
    buffer_load_dwordx4 v4, s[8:11], s54 offen nt lds
    s_add_u32 m0, s62, 1056
    s_nop 0
    buffer_load_dwordx4 v4, s[12:15], 0 offen nt lds
    s_add_u32 m0, s62, 2112
    s_nop 0
    buffer_load_dwordx4 v4, s[12:15], s54 offen nt lds
    s_cmp_lg_u32 s3, 3
    s_cbranch_scc1 L_halo_1
    v_add_u32 v5, -8192, v5
    v_cmp_lt_u32 vcc, 39, v1
    v_mov_b32 v6, 0x80000000
    s_nop 0
    v_cndmask_b32 v5, v6, v5, vcc
    s_mov_b32 m0, 0
    s_nop 0
    buffer_load_dwordx4 v5, s[12:15], 0 offen lds
L_halo_1:
    s_add_u32 m0, s62, 9600
    s_nop 0
    buffer_load_dwordx4 v4, s[16:19], 0 offen nt lds
    s_add_u32 m0, s62, 10656
    s_nop 0
    buffer_load_dwordx4 v4, s[16:19], s54 offen nt lds
    s_load_dword s57, s[36:37], 0
    s_mov_b32 s22, 2097152
    s_mov_b32 s23, 0x20000
    s_mov_b32 s34, 2097152
    s_mov_b32 s35, 0x20000
    s_mov_b32 s38, 20971520
    s_mov_b32 s39, 0x20000
    s_getreg_b32 s55, hwreg(HW_REG_XCC_ID, 0, 3)
    s_mov_b32 s59, 0
    s_lshr_b32 s64, s5, 1
    s_and_b32 s65, s5, 1
    s_lshl_b32 s60, s4, 9
    s_lshl_b32 s61, s3, 7
    s_add_u32 s60, s60, s61
    v_lshl_add_u32 v8, v2, 4, s60
    v_mov_b32 v7, 0
    s_lshl_b32 s60, s2, 7
    s_add_u32 s60, s60, 32768
    v_mov_b32 v9, s60
    s_lshl_b32 s60, s2, 13
    s_lshl_b32 s61, s3, 11
    s_add_u32 s60, s60, s61
    v_lshl_add_u32 v10, v1, 4, s60
    s_mov_b32 s20, s42
    s_mov_b32 s21, s43
    s_mov_b32 s42, 4096
    s_mov_b32 s43, 0x20000
    buffer_load_dwordx4 v[52:55], v8, s[40:43], 0 offen
    s_mov_b64 exec, 1
    buffer_store_dword v7, v9, s[36:39], 0 offen sc1
    s_mov_b64 exec, -1
    buffer_load_dwordx4 v[72:75], v10, s[8:11], 0 offen offset:0 nt
    buffer_load_dwordx4 v[76:79], v10, s[8:11], 0 offen offset:1024 nt
    s_lshl_b32 s61, s4, 5
    s_add_u32 s61, s61, s5
    s_lshl_b32 s60, s61, 2
    s_load_dword s56, s[50:51], s60
    s_lshl_b32 s60, s61, 13
    v_lshl_add_u32 v9, v0, 4, s60
    v_add_u32 v6, 4096, v9
    buffer_load_dwordx4 v[176:179], v9, s[20:23], 0 offen nt
    buffer_load_dwordx4 v[180:183], v6, s[20:23], 0 offen nt
    s_lshl_b32 s62, s5, 2
    s_add_u32 s62, s62, s3
    s_lshl_b32 s62, s62, 9
    v_lshl_add_u32 v9, v1, 7, s62
    v_min_u32 v9, CODE_LAST, v9
    s_mov_b64 exec, 15
    global_load_dword v158, v9, s[52:53]
    s_mov_b64 exec, -1
    s_lshl_b32 s62, s3, 10
    s_add_u32 s62, s62, s60
    s_add_u32 s62, s62, 1024
    s_load_dword s52, s[20:21], s62
    s_add_u32 s62, s62, 4096
    s_min_u32 s62, s62, 2097148
    s_load_dword s53, s[20:21], s62
    s_mov_b32 s32, s30
    s_mov_b32 s33, s31
    s_mov_b32 s30, 1409024
    s_mov_b32 s31, 0x20000
    s_cmp_ge_u32 s3, 2
    s_cselect_b32 s24, s26, s24
    s_cselect_b32 s25, s27, s25
    s_cmp_eq_u32 s64, 15
    s_cselect_b32 s26, 0, 1409024
    s_mov_b32 s27, 0x20000
    v_add_u32 v19, 0, v1
    v_mul_u32_u24 v20, 5462, v19
    v_lshrrev_b32 v20, 16, v20
    v_mul_u32_u24 v21, 12, v20
    v_sub_u32 v21, v19, v21
    v_bfe_u32 v22, v20, 2, 1
    v_lshlrev_b32 v22, 1, v22
    v_sub_u32 v21, v21, v22
    v_add_u32 v22, 12, v21
    v_min_u32 v21, v21, v22
    v_mul_u32_u24 v20, 2752, v20
    v_lshl_add_u32 v16, v21, 4, v20
    v_add_u32 v19, 64, v1
    v_mul_u32_u24 v20, 5462, v19
    v_lshrrev_b32 v20, 16, v20
    v_mul_u32_u24 v21, 12, v20
    v_sub_u32 v21, v19, v21
    v_bfe_u32 v22, v20, 2, 1
    v_lshlrev_b32 v22, 1, v22
    v_sub_u32 v21, v21, v22
    v_add_u32 v22, 12, v21
    v_min_u32 v21, v21, v22
    v_mul_u32_u24 v20, 2752, v20
    v_lshl_add_u32 v17, v21, 4, v20
    v_add_u32 v19, 128, v1
    v_mul_u32_u24 v20, 5462, v19
    v_lshrrev_b32 v20, 16, v20
    v_mul_u32_u24 v21, 12, v20
    v_sub_u32 v21, v19, v21
    v_bfe_u32 v22, v20, 2, 1
    v_lshlrev_b32 v22, 1, v22
    v_sub_u32 v21, v21, v22
    v_add_u32 v22, 12, v21
    v_min_u32 v21, v21, v22
    v_mul_u32_u24 v20, 2752, v20
    v_lshl_add_u32 v18, v21, 4, v20
    s_and_b32 s62, s3, 1
    s_mul_i32 s62, s62, 44032
    s_mul_i32 s63, s64, 192
    s_add_u32 s62, s62, s63
    v_add_u32 v16, s62, v16
    s_sub_u32 s62, s62, 1024
    v_add_u32 v17, s62, v17
    s_sub_u32 s62, s62, 1024
    v_add_u32 v18, s62, v18
    s_sub_u32 s62, s62, 1024
    s_lshr_b32 s60, s3, 1
    s_mul_i32 s60, s60, 6160
    s_and_b32 s62, s3, 1
    s_mul_i32 s62, s62, 3072
    s_add_u32 s48, s60, s62
    v_mul_u32_u24 v157, 5958, v1
    v_lshrrev_b32 v157, 16, v157
    v_mul_u32_u24 v157, 2741, v157
    v_add_lshl_u32 v159, v157, v1, 7
    s_lshl_b32 s62, s3, 3
    v_add_u32 v11, s62, v2
    v_mul_u32_u24 v11, 768, v11
    s_mul_i32 s60, s61, 24576
    s_add_u32 s60, s60, 1048576
    v_lshl_add_u32 v12, v3, 4, s60
    v_add_u32 v11, v11, v12
    v_mul_u32_u24 v88, 1056, v3
    v_lshl_add_u32 v88, v2, 2, v88
    s_lshl_b32 s62, s3, 5
    s_add_u32 s62, s62, 0
    v_add_u32 v88, s62, v88
    v_add_u32 v89, 1056, v88
    v_add_u32 v90, 9600, v88
    v_add_u32 v91, 18048, v88
    v_lshrrev_b32 v14, 3, v0
    v_and_b32 v15, 7, v0
    v_lshlrev_b32 v15, 4, v15
    s_mul_i32 s62, s4, 786432
    s_mul_i32 s63, s5, 768
    s_add_u32 s62, s62, s63
    s_add_u32 s62, s62, 1048576
    v_mul_u32_u24 v12, 24576, v14
    v_add3_u32 v12, v12, v15, s62
    v_mov_b32 v92, 0
    v_mov_b32 v93, 0
    v_mov_b32 v94, 0
    v_mov_b32 v95, 0
    v_lshlrev_b32 v19, 4, v1
    v_and_b32 v19, 0x1f0, v19
    v_lshrrev_b32 v24, 5, v1
    v_mul_u32_u24 v24, 4608, v24
    v_add_u32 v19, v19, v24
    v_add_u32 v19, 143936, v19
    ds_write_b128 v19, v[92:95]
    v_and_b32 v2, 15, v1
    v_lshrrev_b32 v3, 4, v1
    s_lshr_b32 s60, s3, 1
    s_and_b32 s61, s3, 1
    v_lshrrev_b32 v4, 1, v3
    v_and_b32 v5, 1, v3
    v_lshl_add_u32 v6, v4, 4, v2
    v_lshlrev_b32 v7, 3, v5
    v_sub_u32 v6, v6, v7
    s_lshl_b32 s62, s61, 5
    s_add_u32 s62, s62, 9
    v_add_u32 v6, s62, v6
    v_and_b32 v7, 1, v6
    v_and_b32 v6, -2, v6
    v_lshlrev_b32 v6, 1, v6
    v_mul_u32_u24 v7, 4160, v7
    s_mul_i32 s62, s60, 8320
    s_add_u32 s62, s62, 127296
    v_add3_u32 v24, v6, v7, s62
    v_sub_u32 v6, v2, v4
    v_lshlrev_b32 v6, 5, v6
    v_lshl_add_u32 v6, v5, 4, v6
    s_mul_i32 s62, s60, 4608
    s_lshl_b32 s63, s61, 6
    s_sub_u32 s62, s62, s63
    s_add_u32 s62, s62, 144064
    v_add_u32 v25, s62, v6
    v_lshlrev_b32 v26, 4, v0
    v_add_u32 v26, 144448, v26
    v_lshlrev_b32 v27, 5, v0
    v_add_u32 v27, 153152, v27
    v_lshlrev_b32 v6, 4, v2
    v_lshl_add_u32 v6, v3, 2, v6
    s_lshl_b32 s62, s61, 9
    v_add_u32 v6, s62, v6
    v_lshlrev_b32 v28, 2, v6
    v_add_u32 v28, 153152, v28
    v_xor_b32 v7, 4, v6
    v_lshlrev_b32 v29, 1, v7
    s_mul_i32 s62, s60, 4608
    s_add_u32 s62, s62, 144448
    v_add_u32 v29, s62, v29
    s_lshl_b32 s62, s3, 12
    s_add_u32 s62, s62, 127296
    v_lshl_add_u32 v30, v1, 4, s62
    s_lshl_b32 s62, s60, 13
    s_lshl_b32 s63, s61, 11
    s_add_u32 s62, s62, s63
    s_add_u32 s62, s62, 127296
    v_lshl_add_u32 v31, v1, 4, s62
    v_lshlrev_b32 v6, 9, v5
    v_lshl_add_u32 v6, v2, 5, v6
    v_lshl_add_u32 v6, v4, 4, v6
    s_lshl_b32 s62, s4, 5
    s_add_u32 s62, s62, s5
    s_lshl_b32 s62, s62, 1
    s_add_u32 s62, s62, s60
    s_lshl_b32 s62, s62, 12
    s_lshl_b32 s63, s61, 10
    s_add_u32 s62, s62, s63
    s_add_u32 s62, s62, 9437184
    v_add_u32 v14, s62, v6
    s_cmp_eq_u32 s60, 0
    s_mov_b32 s62, 0x01000c0c
    s_mov_b32 s63, 0x03020c0c
    s_cselect_b32 s49, s62, s63
    v_bfe_u32 v6, v1, 2, 2
    v_lshl_add_u32 v6, v3, 2, v6
    v_mul_u32_u24 v6, 192, v6
    v_bfe_u32 v7, v1, 1, 1
    v_mul_u32_u24 v7, 6160, v7
    v_add_u32 v6, v6, v7
    v_and_b32 v7, 1, v1
    s_mul_i32 s62, s3, 3
    v_lshl_add_u32 v8, v5, 1, s62
    v_add_u32 v4, v8, v7
    v_subrev_u32 v10, 12, v4
    v_min_u32 v4, v4, v10
    v_lshl_add_u32 v15, v4, 4, v6
    v_add_u32 v4, 2, v8
    v_subrev_u32 v10, 12, v4
    v_min_u32 v4, v4, v10
    v_lshl_add_u32 v19, v4, 4, v6
    v_lshl_add_u32 v19, v7, 3, v19
    v_add_u32 v20, 65536, v15
    v_add_u32 v21, 65536, v19
    v_add_u32 v22, 131072, v15
    v_add_u32 v23, 131072, v19
    s_lshr_b32 s60, s5, 4
    s_lshl_b32 s61, s4, 1
    s_add_u32 s60, s60, s61
    s_lshl_b32 s60, s60, 7
    s_add_u32 s60, s60, 32768
    v_lshl_add_u32 v4, v1, 11, s60
    v_mov_b32 v5, 1
    v_add_u32 v6, 4608, v26
    v_lshrrev_b32 v7, 1, v3
    v_lshl_add_u32 v7, v2, 1, v7
    v_and_b32 v8, 7, v7
    v_lshrrev_b32 v7, 3, v7
    v_lshlrev_b32 v13, 9, v7
    v_lshl_add_u32 v13, v8, 4, v13
    v_and_b32 v7, 1, v3
    v_lshl_add_u32 v13, v7, 8, v13
    s_and_b32 s60, s3, 1
    s_lshl_b32 s60, s60, 12
    s_add_u32 s60, s60, 4096
    v_add_u32 v13, s60, v13
    v_cmp_eq_u32 vcc, s4, v8
    s_nop 1
    v_cndmask_b32 v8, 0, -1, vcc
    v_mov_b32 v9, 0
    s_cmp_ge_u32 s5, 16
    s_cselect_b32 s60, 0x80000000, 0
    s_cselect_b32 s61, 0, 0x80000000
    v_or_b32 v10, s61, v11
    v_or_b32 v11, s60, v11
    s_cmp_ge_u32 s3, 2
    s_cselect_b32 s60, 0x80000000, 0
    s_cselect_b32 s61, 0, 0x80000000
    v_or_b32 v7, s61, v12
    v_or_b32 v12, s60, v12
    s_waitcnt lgkmcnt(0)
    s_mul_i32 s6, s57, 0x9E3779B1
    s_add_u32 s6, s6, 0x85EBCA6B
    s_not_b32 s7, s6
    s_lshl_b32 s62, s56, 16
    s_and_b32 s63, s56, 0xffff0000
    s_cmp_lt_u32 s3, 2
    s_cselect_b32 s56, s62, s63
    s_add_u32 m0, s48, 65536
    s_mov_b32 s44, 0
    buffer_load_dwordx4 v16, s[24:27], s44 offen offset:0 lds
    s_waitcnt vmcnt(12)
    s_barrier
    v_mov_b32 v59, s6
    v_mov_b32 v63, s6
    v_mov_b32 v67, s6
    ds_read2_b32 v[56:57], v91 offset0:0 offset1:32
    ds_read2_b32 v[60:61], v91 offset0:64 offset1:96
    ds_read2_b32 v[64:65], v91 offset0:128 offset1:160
    ds_read_b32 v58, v91 offset:768
    ds_read_b32 v62, v91 offset:896
    s_waitcnt lgkmcnt(1)
    buffer_store_dwordx4 v[56:59], v11, s[36:39], 0 offen offset:384
    s_waitcnt lgkmcnt(0)
    buffer_store_dwordx4 v[60:63], v11, s[36:39], 0 offen offset:512
    buffer_store_dwordx4 v[64:67], v11, s[36:39], 0 offen offset:640
    s_waitcnt vmcnt(10)
    v_lshlrev_b32 v134, 16, v52
    v_lshlrev_b32 v135, 16, v54
    v_and_b32 v136, 0xffff0000, v52
    v_and_b32 v137, 0xffff0000, v54
    v_lshlrev_b32 v138, 16, v53
    v_lshlrev_b32 v139, 16, v55
    v_and_b32 v140, 0xffff0000, v53
    v_and_b32 v141, 0xffff0000, v55
    s_barrier
    buffer_load_dwordx4 v17, s[24:27], s44 offen offset:1024 lds
    ds_read_b32 v33, v88 offset:640
    ds_read2_b32 v[34:35], v88 offset0:192 offset1:224
    ds_read2_b32 v[36:37], v89 offset0:0 offset1:32
    ds_read2_b32 v[38:39], v89 offset0:64 offset1:96
    ds_read2_b32 v[40:41], v89 offset0:128 offset1:160
    ds_read2_b32 v[42:43], v89 offset0:192 offset1:224
    ds_read2_b32 v[44:45], v90 offset0:0 offset1:32
    ds_read2_b32 v[46:47], v90 offset0:64 offset1:96
    ds_read2_b32 v[48:49], v90 offset0:128 offset1:160
    ds_read2_b32 v[50:51], v90 offset0:192 offset1:224
    s_waitcnt lgkmcnt(9)
    v_lshlrev_b32 v96, 16, v33
    v_and_b32 v97, 0xffff0000, v33
    s_waitcnt lgkmcnt(8)
    v_lshlrev_b32 v98, 16, v34
    v_and_b32 v99, 0xffff0000, v34
    v_lshlrev_b32 v100, 16, v35
    v_and_b32 v101, 0xffff0000, v35
    s_waitcnt lgkmcnt(7)
    v_lshlrev_b32 v102, 16, v36
    v_and_b32 v103, 0xffff0000, v36
    v_lshlrev_b32 v104, 16, v37
    v_and_b32 v105, 0xffff0000, v37
    s_waitcnt lgkmcnt(6)
    v_lshlrev_b32 v106, 16, v38
    v_and_b32 v107, 0xffff0000, v38
    v_lshlrev_b32 v108, 16, v39
    v_and_b32 v109, 0xffff0000, v39
    s_waitcnt lgkmcnt(5)
    v_lshlrev_b32 v110, 16, v40
    v_and_b32 v111, 0xffff0000, v40
    v_lshlrev_b32 v112, 16, v41
    v_and_b32 v113, 0xffff0000, v41
    s_waitcnt lgkmcnt(4)
    v_lshlrev_b32 v114, 16, v42
    v_and_b32 v115, 0xffff0000, v42
    v_lshlrev_b32 v116, 16, v43
    v_and_b32 v117, 0xffff0000, v43
    v_pk_mul_f32 v[142:143], v[96:97], v[140:141]
    v_pk_mul_f32 v[144:145], v[98:99], v[140:141]
    v_pk_mul_f32 v[146:147], v[100:101], v[140:141]
    v_pk_mul_f32 v[148:149], v[102:103], v[140:141]
    v_pk_mul_f32 v[150:151], v[104:105], v[140:141]
    v_pk_mul_f32 v[152:153], v[106:107], v[140:141]
    v_pk_mul_f32 v[154:155], v[108:109], v[140:141]
    v_pk_mul_f32 v[156:157], v[110:111], v[140:141]
    v_pk_fma_f32 v[142:143], v[98:99], v[138:139], v[142:143]
    v_pk_fma_f32 v[144:145], v[100:101], v[138:139], v[144:145]
    v_pk_fma_f32 v[146:147], v[102:103], v[138:139], v[146:147]
    v_pk_fma_f32 v[148:149], v[104:105], v[138:139], v[148:149]
    v_pk_fma_f32 v[150:151], v[106:107], v[138:139], v[150:151]
    v_pk_fma_f32 v[152:153], v[108:109], v[138:139], v[152:153]
    v_pk_fma_f32 v[154:155], v[110:111], v[138:139], v[154:155]
    v_pk_fma_f32 v[156:157], v[112:113], v[138:139], v[156:157]
    v_pk_fma_f32 v[142:143], v[100:101], v[136:137], v[142:143]
    v_pk_fma_f32 v[144:145], v[102:103], v[136:137], v[144:145]
    v_pk_fma_f32 v[146:147], v[104:105], v[136:137], v[146:147]
    v_pk_fma_f32 v[148:149], v[106:107], v[136:137], v[148:149]
    v_pk_fma_f32 v[150:151], v[108:109], v[136:137], v[150:151]
    v_pk_fma_f32 v[152:153], v[110:111], v[136:137], v[152:153]
    v_pk_fma_f32 v[154:155], v[112:113], v[136:137], v[154:155]
    v_pk_fma_f32 v[156:157], v[114:115], v[136:137], v[156:157]
    v_pk_fma_f32 v[142:143], v[102:103], v[134:135], v[142:143]
    v_pk_fma_f32 v[144:145], v[104:105], v[134:135], v[144:145]
    v_pk_fma_f32 v[146:147], v[106:107], v[134:135], v[146:147]
    v_pk_fma_f32 v[148:149], v[108:109], v[134:135], v[148:149]
    v_pk_fma_f32 v[150:151], v[110:111], v[134:135], v[150:151]
    v_pk_fma_f32 v[152:153], v[112:113], v[134:135], v[152:153]
    v_pk_fma_f32 v[154:155], v[114:115], v[134:135], v[154:155]
    v_pk_fma_f32 v[156:157], v[116:117], v[134:135], v[156:157]
    s_waitcnt lgkmcnt(3)
    v_lshlrev_b32 v118, 16, v44
    v_and_b32 v119, 0xffff0000, v44
    v_lshlrev_b32 v120, 16, v45
    v_and_b32 v121, 0xffff0000, v45
    s_waitcnt lgkmcnt(2)
    v_lshlrev_b32 v122, 16, v46
    v_and_b32 v123, 0xffff0000, v46
    v_lshlrev_b32 v124, 16, v47
    v_and_b32 v125, 0xffff0000, v47
    s_waitcnt lgkmcnt(1)
    v_lshlrev_b32 v126, 16, v48
    v_and_b32 v127, 0xffff0000, v48
    v_lshlrev_b32 v128, 16, v49
    v_and_b32 v129, 0xffff0000, v49
    s_waitcnt lgkmcnt(0)
    v_lshlrev_b32 v130, 16, v50
    v_and_b32 v131, 0xffff0000, v50
    v_lshlrev_b32 v132, 16, v51
    v_and_b32 v133, 0xffff0000, v51
    v_mov_b32 v47, s6
    v_mov_b32 v51, s6
    v_mov_b32 v55, s6
    v_pk_mul_f32 v[142:143], v[142:143], v[118:119]
    v_pk_mul_f32 v[144:145], v[144:145], v[120:121]
    v_pk_mul_f32 v[146:147], v[146:147], v[122:123]
    v_pk_mul_f32 v[148:149], v[148:149], v[124:125]
    v_pk_mul_f32 v[150:151], v[150:151], v[126:127]
    v_pk_mul_f32 v[152:153], v[152:153], v[128:129]
    v_pk_mul_f32 v[154:155], v[154:155], v[130:131]
    v_pk_mul_f32 v[156:157], v[156:157], v[132:133]
    v_cvt_pk_bf16_f32 v44, v156, v154
    v_cvt_pk_bf16_f32 v45, v152, v150
    v_cvt_pk_bf16_f32 v46, v149, v147
    v_cvt_pk_bf16_f32 v48, v148, v146
    v_cvt_pk_bf16_f32 v49, v144, v142
    v_cvt_pk_bf16_f32 v50, v145, v143
    v_cvt_pk_bf16_f32 v52, v157, v155
    v_cvt_pk_bf16_f32 v53, v153, v151
    buffer_store_dwordx4 v[44:47], v11, s[36:39], 0 offen offset:0
    buffer_store_dwordx4 v[48:51], v11, s[36:39], 0 offen offset:128
    buffer_store_dwordx4 v[52:55], v11, s[36:39], 0 offen offset:256
    s_mul_i32 s60, s2, 1408
    s_min_u32 s60, s60, 350848
    v_add_u32 v157, s60, v159
    s_cmp_eq_u32 s3, 1
    s_cselect_b32 s66, s28, s24
    s_cselect_b32 s67, s29, s25
    s_cselect_b32 s60, 0, 1
    s_cmp_eq_u32 s3, 3
    s_cselect_b32 s60, 0, s60
    s_cmp_eq_u32 s60, 0
    s_cbranch_scc1 L_mp_2
    s_mov_b32 exec_lo, 0xffffffff
    s_mov_b32 exec_hi, 0xfff
    s_cmp_eq_u32 s3, 1
    s_cselect_b32 exec_lo, -1, exec_lo
    s_cselect_b32 exec_hi, 0xfff, exec_hi
    global_load_dword a191, v157, s[66:67]
    s_mov_b64 exec, -1
L_mp_2:
    buffer_load_dwordx4 v18, s[24:27], s44 offen offset:2048 lds
    s_add_u32 m0, s48, 77888
    s_mov_b32 s44, 88064
    v_mov_b32 v112, 0
    v_mov_b32 v113, 0
    v_mov_b32 v114, 0
    v_mov_b32 v115, 0
    s_mov_b32 s100, 0x3f803f80
    s_waitcnt vmcnt(13)
    v_dot2c_f32_bf16 v112, s100, v72
    v_dot2c_f32_bf16 v113, v72, v72
    s_waitcnt vmcnt(12)
    v_dot2c_f32_bf16 v114, s100, v76
    v_dot2c_f32_bf16 v115, v76, v76
    v_dot2c_f32_bf16 v112, s100, v73
    v_dot2c_f32_bf16 v113, v73, v73
    v_dot2c_f32_bf16 v114, s100, v77
    v_dot2c_f32_bf16 v115, v77, v77
    v_dot2c_f32_bf16 v112, s100, v74
    v_dot2c_f32_bf16 v113, v74, v74
    v_dot2c_f32_bf16 v114, s100, v78
    v_dot2c_f32_bf16 v115, v78, v78
    v_dot2c_f32_bf16 v112, s100, v75
    v_dot2c_f32_bf16 v113, v75, v75
    v_dot2c_f32_bf16 v114, s100, v79
    v_dot2c_f32_bf16 v115, v79, v79
    v_add_f32_dpp v112, v112, v112 row_shr:1 row_mask:0xf bank_mask:0xf bound_ctrl:0
    v_add_f32_dpp v113, v113, v113 row_shr:1 row_mask:0xf bank_mask:0xf bound_ctrl:0
    v_add_f32_dpp v114, v114, v114 row_shr:1 row_mask:0xf bank_mask:0xf bound_ctrl:0
    v_add_f32_dpp v115, v115, v115 row_shr:1 row_mask:0xf bank_mask:0xf bound_ctrl:0
    v_add_f32_dpp v112, v112, v112 row_shr:2 row_mask:0xf bank_mask:0xf bound_ctrl:0
    v_add_f32_dpp v113, v113, v113 row_shr:2 row_mask:0xf bank_mask:0xf bound_ctrl:0
    v_add_f32_dpp v114, v114, v114 row_shr:2 row_mask:0xf bank_mask:0xf bound_ctrl:0
    v_add_f32_dpp v115, v115, v115 row_shr:2 row_mask:0xf bank_mask:0xf bound_ctrl:0
    v_add_f32_dpp v112, v112, v112 row_shr:4 row_mask:0xf bank_mask:0xf bound_ctrl:0
    v_add_f32_dpp v113, v113, v113 row_shr:4 row_mask:0xf bank_mask:0xf bound_ctrl:0
    v_add_f32_dpp v114, v114, v114 row_shr:4 row_mask:0xf bank_mask:0xf bound_ctrl:0
    v_add_f32_dpp v115, v115, v115 row_shr:4 row_mask:0xf bank_mask:0xf bound_ctrl:0
    v_add_f32_dpp v112, v112, v112 row_shr:8 row_mask:0xf bank_mask:0xf bound_ctrl:0
    v_add_f32_dpp v113, v113, v113 row_shr:8 row_mask:0xf bank_mask:0xf bound_ctrl:0
    v_add_f32_dpp v114, v114, v114 row_shr:8 row_mask:0xf bank_mask:0xf bound_ctrl:0
    v_add_f32_dpp v115, v115, v115 row_shr:8 row_mask:0xf bank_mask:0xf bound_ctrl:0
    v_add_f32_dpp v112, v112, v112 row_bcast:15 row_mask:0xa bank_mask:0xf
    v_add_f32_dpp v113, v113, v113 row_bcast:15 row_mask:0xa bank_mask:0xf
    v_add_f32_dpp v114, v114, v114 row_bcast:15 row_mask:0xa bank_mask:0xf
    v_add_f32_dpp v115, v115, v115 row_bcast:15 row_mask:0xa bank_mask:0xf
    v_add_f32_dpp v112, v112, v112 row_bcast:31 row_mask:0xc bank_mask:0xf
    v_add_f32_dpp v113, v113, v113 row_bcast:31 row_mask:0xc bank_mask:0xf
    v_add_f32_dpp v114, v114, v114 row_bcast:31 row_mask:0xc bank_mask:0xf
    v_add_f32_dpp v115, v115, v115 row_bcast:31 row_mask:0xc bank_mask:0xf
    s_mov_b32 s60, 0x3b000000
    v_mul_f32 v112, s60, v112
    v_mul_f32 v113, s60, v113
    v_mul_f32 v114, s60, v114
    v_mul_f32 v115, s60, v115
    v_fma_f32 v113, -v112, v112, v113
    v_fma_f32 v115, -v114, v114, v115
    v_max_f32 v113, 0, v113
    v_max_f32 v115, 0, v115
    v_cvt_pk_bf16_f32 v116, v113, v115
    s_mov_b32 s60, 0x3727c5ac
    v_lshlrev_b32 v118, 16, v116
    v_and_b32 v119, 0xffff0000, v116
    v_add_f32 v118, s60, v118
    v_add_f32 v119, s60, v119
    v_cvt_pk_bf16_f32 v116, v118, v119
    v_lshlrev_b32 v118, 16, v116
    v_and_b32 v119, 0xffff0000, v116
    v_sqrt_f32 v118, v118
    v_sqrt_f32 v119, v119
    s_nop 0
    v_cvt_pk_bf16_f32 v116, v118, v119
    v_lshlrev_b32 v118, 16, v116
    v_and_b32 v119, 0xffff0000, v116
    v_rcp_f32 v118, v118
    v_rcp_f32 v119, v119
    v_cvt_pk_bf16_f32 v124, v112, v118
    v_cvt_pk_bf16_f32 v125, v114, v119
    v_mov_b32 v126, s6
    s_xor_b32 s60, s7, s55
    v_mov_b32 v127, s60
    s_lshl_b32 s60, s5, 9
    s_lshl_b32 s61, s3, 7
    s_add_u32 s60, s60, s61
    s_lshl_b32 s61, s4, 4
    s_add_u32 s60, s60, s61
    s_add_u32 s60, s60, 4096
    v_mov_b32 v116, s60
    s_lshl_b64 exec, 1, 63
    buffer_store_dwordx4 v[124:127], v116, s[36:39], 0 offen sc1
    s_mov_b64 exec, -1
    v_lshlrev_b32 v114, 4, v0
    v_add_u32 v114, 127328, v114
    v_mov_b32 v112, s52
    v_mov_b32 v113, s53
    s_waitcnt vmcnt(12)
    v_mov_b32_dpp v112, v176 wave_shl:1 row_mask:0xf bank_mask:0xf
    s_waitcnt vmcnt(11)
    v_mov_b32_dpp v113, v180 wave_shl:1 row_mask:0xf bank_mask:0xf
    v_alignbit_b32 v96, v177, v176, 16
    v_alignbit_b32 v97, v178, v177, 16
    v_alignbit_b32 v98, v179, v178, 16
    v_alignbit_b32 v99, v112, v179, 16
    ds_write_b128 v114, v[176:179] offset:0
    ds_write_b128 v114, v[96:99] offset:4160
    v_alignbit_b32 v100, v181, v180, 16
    v_alignbit_b32 v101, v182, v181, 16
    v_alignbit_b32 v102, v183, v182, 16
    v_alignbit_b32 v103, v113, v183, 16
    ds_write_b128 v114, v[180:183] offset:8320
    ds_write_b128 v114, v[100:103] offset:12480
    v_mov_b32 v104, 0
    v_mov_b32 v105, 0
    v_mov_b32 v106, 0
    v_mov_b32 v108, 0
    v_mov_b32 v109, 0
    v_mov_b32 v110, 0
    v_lshlrev_b32 v107, 16, v176
    v_lshlrev_b32 v111, 16, v180
    s_cmp_lg_u32 s3, 0
    s_cbranch_scc1 L_kp_3
    v_mov_b32 v115, 127296
    s_mov_b64 exec, 1
    ds_write_b128 v115, v[92:95] offset:0
    ds_write_b128 v115, v[92:95] offset:16
    ds_write_b128 v115, v[92:95] offset:4160
    ds_write_b128 v115, v[104:107] offset:4176
    ds_write_b128 v115, v[92:95] offset:8320
    ds_write_b128 v115, v[92:95] offset:8336
    ds_write_b128 v115, v[92:95] offset:12480
    ds_write_b128 v115, v[108:111] offset:12496
    s_mov_b64 exec, -1
L_kp_3:
    v_mov_b32 v0, v159
    buffer_store_dwordx4 v[44:47], v10, s[36:39], 0 offen offset:0
    buffer_store_dwordx4 v[48:51], v10, s[36:39], 0 offen offset:128
    s_waitcnt lgkmcnt(0)
    s_barrier
    buffer_load_dwordx4 v16, s[24:27], s44 offen offset:0 lds
    buffer_load_dwordx4 v17, s[24:27], s44 offen offset:1024 lds
    ds_read2_b32 v[128:129], v24 offset0:0 offset1:1
    ds_read2_b32 v[130:131], v24 offset0:2 offset1:3
    ds_read2_b32 v[132:133], v24 offset0:32 offset1:33
    ds_read2_b32 v[134:135], v24 offset0:34 offset1:35
    ds_read2_b32 v[136:137], v24 offset0:64 offset1:65
    ds_read2_b32 v[138:139], v24 offset0:66 offset1:67
    ds_read2_b32 v[140:141], v24 offset0:96 offset1:97
    ds_read2_b32 v[142:143], v24 offset0:98 offset1:99
    buffer_store_dwordx4 v[52:55], v10, s[36:39], 0 offen offset:256
    buffer_load_dwordx4 v18, s[24:27], s44 offen offset:2048 lds
    s_add_u32 m0, s48, 90240
    s_mov_b32 s44, 176128
    ds_read2_b32 v[144:145], v24 offset0:128 offset1:129
    ds_read2_b32 v[146:147], v24 offset0:130 offset1:131
    ds_read2_b32 v[148:149], v24 offset0:160 offset1:161
    ds_read2_b32 v[150:151], v24 offset0:162 offset1:163
    ds_read2_b32 v[152:153], v24 offset0:192 offset1:193
    ds_read2_b32 v[154:155], v24 offset0:194 offset1:195
    ds_read2_b32 v[156:157], v24 offset0:224 offset1:225
    s_waitcnt vmcnt(16)
    ds_read2_b32 v[158:159], v24 offset0:226 offset1:227
    buffer_store_dwordx4 v[56:59], v10, s[36:39], 0 offen offset:384
    buffer_load_dwordx4 v16, s[24:27], s44 offen offset:0 lds
    buffer_load_dwordx4 v[68:71], v12, s[36:39], 0 offen offset:0 sc1
    buffer_load_dwordx4 v[72:75], v12, s[36:39], 0 offen offset:128 sc1
    buffer_load_dwordx4 v[76:79], v12, s[36:39], 0 offen offset:256 sc1
    buffer_load_dwordx4 v[80:83], v12, s[36:39], 0 offen offset:384 sc1
    buffer_load_dwordx4 v[84:87], v12, s[36:39], 0 offen offset:512 sc1
    buffer_load_dwordx4 v[88:91], v12, s[36:39], 0 offen offset:640 sc1
    v_add_u32 v24, 1024, v24
    ds_read2_b32 v[160:161], v24 offset0:0 offset1:1
    ds_read2_b32 v[162:163], v24 offset0:2 offset1:3
    ds_read2_b32 v[164:165], v24 offset0:32 offset1:33
    buffer_load_dwordx4 v17, s[24:27], s44 offen offset:1024 lds
    ds_read2_b32 v[166:167], v24 offset0:34 offset1:35
    ds_read2_b32 v[168:169], v24 offset0:64 offset1:65
    ds_read2_b32 v[170:171], v24 offset0:66 offset1:67
    ds_read2_b32 v[172:173], v24 offset0:96 offset1:97
    ds_read2_b32 v[174:175], v24 offset0:98 offset1:99
    buffer_store_dwordx4 v[60:63], v10, s[36:39], 0 offen offset:512
    ds_read2_b32 v[176:177], v24 offset0:128 offset1:129
    buffer_load_dwordx4 v18, s[24:27], s44 offen offset:2048 lds
    ds_read2_b32 v[178:179], v24 offset0:130 offset1:131
    ds_read2_b32 v[180:181], v24 offset0:160 offset1:161
    ds_read2_b32 v[182:183], v24 offset0:162 offset1:163
    ds_read2_b32 v[184:185], v24 offset0:192 offset1:193
    ds_read2_b32 v[186:187], v24 offset0:194 offset1:195
    ds_read2_b32 v[188:189], v24 offset0:224 offset1:225
    ds_read2_b32 v[190:191], v24 offset0:226 offset1:227
    buffer_store_dwordx4 v[64:67], v10, s[36:39], 0 offen offset:640
    v_add_u32 v24, 1024, v24
    ds_read2_b32 v[192:193], v24 offset0:0 offset1:1
    ds_read2_b32 v[194:195], v24 offset0:2 offset1:3
    ds_read2_b32 v[196:197], v24 offset0:32 offset1:33
    ds_read2_b32 v[198:199], v24 offset0:34 offset1:35
    ds_read2_b32 v[200:201], v24 offset0:64 offset1:65
    ds_read2_b32 v[202:203], v24 offset0:66 offset1:67
    ds_read2_b32 v[204:205], v24 offset0:96 offset1:97
    ds_read2_b32 v[206:207], v24 offset0:98 offset1:99
    ds_read2_b32 v[208:209], v24 offset0:128 offset1:129
    ds_read2_b32 v[210:211], v24 offset0:130 offset1:131
    ds_read2_b32 v[212:213], v24 offset0:160 offset1:161
    ds_read2_b32 v[214:215], v24 offset0:162 offset1:163
    ds_read2_b32 v[216:217], v24 offset0:192 offset1:193
    ds_read2_b32 v[218:219], v24 offset0:194 offset1:195
    ds_read2_b32 v[220:221], v24 offset0:224 offset1:225
    ds_read2_b32 v[222:223], v24 offset0:226 offset1:227
    v_add_u32 v24, 1024, v24
    ds_read2_b32 v[224:225], v24 offset0:0 offset1:1
    ds_read2_b32 v[226:227], v24 offset0:2 offset1:3
    ds_read2_b32 v[228:229], v24 offset0:32 offset1:33
    ds_read2_b32 v[230:231], v24 offset0:34 offset1:35
    ds_read2_b32 v[232:233], v24 offset0:64 offset1:65
    ds_read2_b32 v[234:235], v24 offset0:66 offset1:67
    ds_read2_b32 v[236:237], v24 offset0:96 offset1:97
    ds_read2_b32 v[238:239], v24 offset0:98 offset1:99
    ds_read2_b32 v[240:241], v24 offset0:128 offset1:129
    ds_read2_b32 v[242:243], v24 offset0:130 offset1:131
    ds_read2_b32 v[244:245], v24 offset0:160 offset1:161
    ds_read2_b32 v[246:247], v24 offset0:162 offset1:163
    ds_read2_b32 v[248:249], v24 offset0:192 offset1:193
    ds_read2_b32 v[250:251], v24 offset0:194 offset1:195
    ds_read2_b32 v[252:253], v24 offset0:224 offset1:225
    ds_read2_b32 v[254:255], v24 offset0:226 offset1:227
    s_movk_i32 s51, 0
    buffer_load_dwordx4 a[208:211], v13, s[36:39], s51 offen offset:0 sc1
    buffer_load_dwordx4 a[212:215], v13, s[36:39], s51 offen offset:128 sc1
    buffer_load_dwordx4 a[216:219], v13, s[36:39], s51 offen offset:2048 sc1
    buffer_load_dwordx4 a[220:223], v13, s[36:39], s51 offen offset:2176 sc1
    s_cmp_ge_u32 s3, 2
    s_cbranch_scc1 L_oi_4
    s_waitcnt vmcnt(12)
    v_bitop3_b32 v92, v71, v75, s6 bitop3:0x7e
    s_waitcnt vmcnt(11)
    v_bitop3_b32 v92, v92, v79, s6 bitop3:0xf6
    s_waitcnt vmcnt(10)
    v_bitop3_b32 v92, v92, v83, s6 bitop3:0xf6
    s_waitcnt vmcnt(9)
    v_bitop3_b32 v92, v92, v87, s6 bitop3:0xf6
    s_waitcnt vmcnt(8)
    v_bitop3_b32 v92, v92, v91, s6 bitop3:0xf6
    v_cmp_ne_u32 vcc, 0, v92
    s_cbranch_vccnz L_u_retry
L_u_ok:
    s_waitcnt vmcnt(12)
    ds_write2_b64 v26, v[68:69], v[72:73] offset0:0 offset1:1
    s_waitcnt vmcnt(11)
    ds_write_b64 v6, v[76:77]
    s_waitcnt vmcnt(12)
    ds_write2_b32 v6, v70, v74 offset0:2 offset1:3
    s_waitcnt vmcnt(9)
    ds_write2_b64 v27, v[80:81], v[84:85] offset0:0 offset1:1
    s_waitcnt vmcnt(8)
    ds_write_b64 v27, v[88:89] offset:16
    s_waitcnt vmcnt(9)
    ds_write2_b32 v27, v82, v86 offset0:6 offset1:7
L_oi_4:
    s_waitcnt lgkmcnt(0)
    s_barrier
    s_add_u32 m0, s48, 102592
    s_mov_b32 s44, 264192
    buffer_load_dwordx4 v16, s[24:27], s44 offen offset:0 lds
L_conv:
    buffer_load_dwordx4 v17, s[24:27], s44 offen offset:1024 lds
    ds_read_b128 v[64:67], v25 offset:0
    s_waitcnt vmcnt(15)
    ds_read_b128 v[68:71], v25 offset:128
    s_waitcnt vmcnt(14)
    ds_read_b128 v[72:75], v25 offset:256
    s_waitcnt vmcnt(13)
    ds_read_b128 v[76:79], v25 offset:384
    s_waitcnt vmcnt(12)
    ds_read_b128 v[80:83], v25 offset:512
    s_waitcnt lgkmcnt(4)
    v_mfma_f32_16x16x32_bf16 v[32:35], v[140:143], v[64:67], 0
    s_waitcnt vmcnt(11)
    ds_read_b128 v[84:87], v25 offset:640
    ds_read_b64 v[112:113], v29 offset:0
    v_mfma_f32_16x16x32_bf16 v[36:39], v[156:159], v[64:67], 0
    ds_read_b64 v[114:115], v29 offset:512
    s_waitcnt vmcnt(10)
    ds_read_b128 v[88:91], v28 offset:0
    ds_read_b128 v[92:95], v28 offset:1024
    v_mfma_f32_16x16x32_bf16 v[40:43], v[172:175], v[64:67], 0
    buffer_load_dwordx4 a[224:227], v7, s[36:39], 0 offen offset:0 sc1
    buffer_load_dwordx4 a[228:231], v7, s[36:39], 0 offen offset:128 sc1
    buffer_load_dwordx4 a[232:235], v7, s[36:39], 0 offen offset:256 sc1
    v_mfma_f32_16x16x32_bf16 v[44:47], v[188:191], v[64:67], 0
    buffer_load_dwordx4 a[236:239], v7, s[36:39], 0 offen offset:384 sc1
    buffer_load_dwordx4 a[240:243], v7, s[36:39], 0 offen offset:512 sc1
    buffer_load_dwordx4 a[244:247], v7, s[36:39], 0 offen offset:640 sc1
    s_waitcnt lgkmcnt(8)
    v_mfma_f32_16x16x32_bf16 v[32:35], v[136:139], v[68:71], v[32:35]
    ds_read_b128 v[64:67], v25 offset:768
    v_mfma_f32_16x16x32_bf16 v[36:39], v[152:155], v[68:71], v[36:39]
    v_mfma_f32_16x16x32_bf16 v[40:43], v[168:171], v[68:71], v[40:43]
    v_mfma_f32_16x16x32_bf16 v[44:47], v[184:187], v[68:71], v[44:47]
    s_waitcnt lgkmcnt(8)
    v_mfma_f32_16x16x32_bf16 v[32:35], v[132:135], v[72:75], v[32:35]
    ds_read_b128 v[68:71], v25 offset:896
    s_waitcnt lgkmcnt(5)
    v_and_b32 v104, 0xffff0000, v113
    v_lshlrev_b32 v105, 16, v113
    v_mfma_f32_16x16x32_bf16 v[36:39], v[148:151], v[72:75], v[36:39]
    v_and_b32 v106, 0xffff0000, v112
    v_lshlrev_b32 v107, 16, v112
    s_waitcnt lgkmcnt(4)
    v_and_b32 v108, 0xffff0000, v115
    v_mfma_f32_16x16x32_bf16 v[40:43], v[164:167], v[72:75], v[40:43]
    buffer_load_dwordx4 v18, s[24:27], s44 offen offset:2048 lds
    s_add_u32 m0, s48, 114944
    s_mov_b32 s44, 352256
    v_lshlrev_b32 v109, 16, v115
    v_and_b32 v110, 0xffff0000, v114
    v_lshlrev_b32 v111, 16, v114
    v_mfma_f32_16x16x32_bf16 v[44:47], v[180:183], v[72:75], v[44:47]
    buffer_load_dwordx4 v16, s[24:27], s44 offen offset:0 lds
    s_waitcnt lgkmcnt(3)
    v_perm_b32 v88, v88, v88, s49
    v_perm_b32 v89, v89, v89, s49
    v_perm_b32 v90, v90, v90, s49
    v_mfma_f32_16x16x32_bf16 v[32:35], v[128:131], v[76:79], v[32:35]
    ds_read_b128 v[72:75], v25 offset:1024
    v_perm_b32 v91, v91, v91, s49
    s_waitcnt lgkmcnt(3)
    v_perm_b32 v92, v92, v92, s49
    v_mfma_f32_16x16x32_bf16 v[36:39], v[144:147], v[76:79], v[36:39]
    v_perm_b32 v93, v93, v93, s49
    v_perm_b32 v94, v94, v94, s49
    v_perm_b32 v95, v95, v95, s49
    v_mfma_f32_16x16x32_bf16 v[40:43], v[160:163], v[76:79], v[40:43]
    s_waitcnt vmcnt(13)
    v_accvgpr_read_b32 v120, a211
    s_waitcnt vmcnt(12)
    v_accvgpr_read_b32 v121, a215
    s_waitcnt vmcnt(11)
    v_accvgpr_read_b32 v122, a219
    v_mfma_f32_16x16x32_bf16 v[44:47], v[176:179], v[76:79], v[44:47]
    buffer_load_dwordx4 v17, s[24:27], s44 offen offset:1024 lds
    s_waitcnt vmcnt(11)
    v_accvgpr_read_b32 v123, a223
    v_bitop3_b32 v126, v120, v121, s7 bitop3:0x7e
    v_bitop3_b32 v127, v122, v123, s7 bitop3:0x7e
    v_mfma_f32_16x16x32_bf16 v[36:39], v[140:143], v[80:83], v[36:39]
    ds_read_b128 v[76:79], v25 offset:1152
    v_or_b32 v126, v126, v127
    v_cmp_lt_u32 vcc, 7, v126
    s_cbranch_vccnz L_st0_retry
L_st0_ok:
    v_mfma_f32_16x16x32_bf16 v[40:43], v[156:159], v[80:83], v[40:43]
    s_xor_b32 s60, s7, s55
    v_bitop3_b32 v124, v120, v122, s60 bitop3:0x7e
    v_and_b32 v124, v124, v8
    v_or_b32 v9, v9, v124
    v_mfma_f32_16x16x32_bf16 v[44:47], v[172:175], v[80:83], v[44:47]
    v_accvgpr_read_b32 v96, a208
    v_accvgpr_read_b32 v97, a209
    v_accvgpr_read_b32 v98, a212
    v_mfma_f32_16x16x32_bf16 v[36:39], v[136:139], v[84:87], v[36:39]
    ds_read_b128 v[80:83], v25 offset:1280
    v_accvgpr_read_b32 v99, a213
    v_accvgpr_read_b32 v100, a216
    v_mfma_f32_16x16x32_bf16 v[40:43], v[152:155], v[84:87], v[40:43]
    v_accvgpr_read_b32 v101, a217
    v_accvgpr_read_b32 v102, a220
    v_accvgpr_read_b32 v103, a221
    v_mfma_f32_16x16x32_bf16 v[44:47], v[168:171], v[84:87], v[44:47]
    buffer_load_dwordx4 v18, s[24:27], s44 offen offset:2048 lds
    s_add_u32 m0, s48, 0
    s_mov_b32 s44, 440320
    v_and_b32 v116, 0xffff0000, v96
    v_and_b32 v117, 0xffff0000, v97
    v_and_b32 v118, 0xffff0000, v98
    s_waitcnt lgkmcnt(4)
    v_mfma_f32_16x16x32_bf16 v[36:39], v[132:135], v[64:67], v[36:39]
    ds_read_b128 v[84:87], v25 offset:1408
    v_and_b32 v119, 0xffff0000, v99
    v_and_b32 v124, 0xffff0000, v100
    v_mfma_f32_16x16x32_bf16 v[40:43], v[148:151], v[64:67], v[40:43]
    v_and_b32 v125, 0xffff0000, v101
    v_and_b32 v126, 0xffff0000, v102
    v_and_b32 v127, 0xffff0000, v103
    v_mfma_f32_16x16x32_bf16 v[44:47], v[164:167], v[64:67], v[44:47]
    v_lshlrev_b32 v96, 16, v96
    v_lshlrev_b32 v97, 16, v97
    v_lshlrev_b32 v98, 16, v98
    s_waitcnt lgkmcnt(4)
    v_mfma_f32_16x16x32_bf16 v[36:39], v[128:131], v[68:71], v[36:39]
    ds_read_b128 v[64:67], v25 offset:1536
    v_lshlrev_b32 v99, 16, v99
    v_lshlrev_b32 v100, 16, v100
    v_mfma_f32_16x16x32_bf16 v[40:43], v[144:147], v[68:71], v[40:43]
    v_lshlrev_b32 v101, 16, v101
    v_lshlrev_b32 v102, 16, v102
    v_lshlrev_b32 v103, 16, v103
    v_mfma_f32_16x16x32_bf16 v[44:47], v[160:163], v[68:71], v[44:47]
    buffer_load_dwordx4 v16, s[24:27], s44 offen offset:0 lds
    v_sub_f32 v96, v88, v96
    v_sub_f32 v97, v89, v97
    v_sub_f32 v98, v90, v98
    s_waitcnt lgkmcnt(4)
    v_mfma_f32_16x16x32_bf16 v[40:43], v[140:143], v[72:75], v[40:43]
    ds_read_b128 v[68:71], v25 offset:1664
    v_sub_f32 v99, v91, v99
    v_sub_f32 v100, v92, v100
    v_mfma_f32_16x16x32_bf16 v[44:47], v[156:159], v[72:75], v[44:47]
    v_sub_f32 v101, v93, v101
    v_sub_f32 v102, v94, v102
    v_sub_f32 v103, v95, v103
    s_waitcnt lgkmcnt(4)
    v_mfma_f32_16x16x32_bf16 v[40:43], v[136:139], v[76:79], v[40:43]
    ds_read_b128 v[72:75], v25 offset:1792
    v_mul_f32 v96, v96, v116
    v_mul_f32 v97, v97, v117
    v_mfma_f32_16x16x32_bf16 v[44:47], v[152:155], v[76:79], v[44:47]
    v_mul_f32 v98, v98, v118
    v_mul_f32 v99, v99, v119
    v_mul_f32 v100, v100, v124
    s_waitcnt lgkmcnt(4)
    v_mfma_f32_16x16x32_bf16 v[40:43], v[132:135], v[80:83], v[40:43]
    ds_read_b128 v[76:79], v25 offset:1920
    v_mul_f32 v101, v101, v125
    v_mul_f32 v102, v102, v126
    v_mfma_f32_16x16x32_bf16 v[44:47], v[148:151], v[80:83], v[44:47]
    buffer_load_dwordx4 v17, s[24:27], s44 offen offset:1024 lds
    v_mul_f32 v103, v103, v127
    s_waitcnt lgkmcnt(4)
    v_mfma_f32_16x16x32_bf16 v[40:43], v[128:131], v[84:87], v[40:43]
    ds_read_b128 v[80:83], v25 offset:0
    v_mfma_f32_16x16x32_bf16 v[44:47], v[144:147], v[84:87], v[44:47]
    s_waitcnt lgkmcnt(4)
    v_mfma_f32_16x16x32_bf16 v[44:47], v[140:143], v[64:67], v[44:47]
    ds_read_b128 v[84:87], v25 offset:128
    s_waitcnt lgkmcnt(4)
    v_mfma_f32_16x16x32_bf16 v[44:47], v[136:139], v[68:71], v[44:47]
    ds_read_b128 v[64:67], v25 offset:256
    s_waitcnt lgkmcnt(4)
    v_mfma_f32_16x16x32_bf16 v[44:47], v[132:135], v[72:75], v[44:47]
    ds_read_b128 v[68:71], v25 offset:384
    s_waitcnt lgkmcnt(4)
    v_mfma_f32_16x16x32_bf16 v[44:47], v[128:131], v[76:79], v[44:47]
    ds_read_b128 v[72:75], v25 offset:512
    s_waitcnt lgkmcnt(4)
    v_mfma_f32_16x16x32_bf16 v[48:51], v[204:207], v[80:83], 0
    ds_read_b128 v[76:79], v25 offset:640
    v_mfma_f32_16x16x32_bf16 v[52:55], v[220:223], v[80:83], 0
    ds_write_b128 v30, v[32:35] offset:0
    ds_write_b128 v30, v[36:39] offset:1024
    ds_write_b128 v30, v[40:43] offset:2048
    v_mfma_f32_16x16x32_bf16 v[56:59], v[236:239], v[80:83], 0
    ds_write_b128 v30, v[44:47] offset:3072
    v_mfma_f32_16x16x32_bf16 v[60:63], v[252:255], v[80:83], 0
    buffer_load_dwordx4 v18, s[24:27], s44 offen offset:2048 lds
    s_add_u32 m0, s48, 12352
    s_mov_b32 s44, 528384
    s_waitcnt lgkmcnt(8)
    v_mfma_f32_16x16x32_bf16 v[48:51], v[200:203], v[84:87], v[48:51]
    ds_read_b128 v[80:83], v25 offset:768
    v_mfma_f32_16x16x32_bf16 v[52:55], v[216:219], v[84:87], v[52:55]
    v_mfma_f32_16x16x32_bf16 v[56:59], v[232:235], v[84:87], v[56:59]
    buffer_load_dwordx4 v16, s[24:27], s44 offen offset:0 lds
    v_mfma_f32_16x16x32_bf16 v[60:63], v[248:251], v[84:87], v[60:63]
    s_waitcnt lgkmcnt(8)
    v_mfma_f32_16x16x32_bf16 v[48:51], v[196:199], v[64:67], v[48:51]
    ds_read_b128 v[84:87], v25 offset:896
    v_mfma_f32_16x16x32_bf16 v[52:55], v[212:215], v[64:67], v[52:55]
    v_mfma_f32_16x16x32_bf16 v[56:59], v[228:231], v[64:67], v[56:59]
    s_waitcnt lgkmcnt(2)
    s_barrier
    ds_read_b128 v[32:35], v31 offset:0
    ds_read_b128 v[36:39], v31 offset:1024
    ds_read_b128 v[40:43], v31 offset:4096
    ds_read_b128 v[44:47], v31 offset:5120
    v_mfma_f32_16x16x32_bf16 v[60:63], v[244:247], v[64:67], v[60:63]
    v_mfma_f32_16x16x32_bf16 v[48:51], v[192:195], v[68:71], v[48:51]
    ds_read_b128 v[64:67], v25 offset:1024
    v_mfma_f32_16x16x32_bf16 v[52:55], v[208:211], v[68:71], v[52:55]
    buffer_load_dwordx4 v17, s[24:27], s44 offen offset:1024 lds
    v_mfma_f32_16x16x32_bf16 v[56:59], v[224:227], v[68:71], v[56:59]
    v_mfma_f32_16x16x32_bf16 v[60:63], v[240:243], v[68:71], v[60:63]
    v_mfma_f32_16x16x32_bf16 v[48:51], v[188:191], v[72:75], v[48:51]
    ds_read_b128 v[68:71], v25 offset:1152
    v_mfma_f32_16x16x32_bf16 v[52:55], v[204:207], v[72:75], v[52:55]
    v_mfma_f32_16x16x32_bf16 v[56:59], v[220:223], v[72:75], v[56:59]
    s_waitcnt lgkmcnt(5)
    v_fma_f32 v104, v104, s56, v32
    v_fma_f32 v105, v105, s56, v33
    v_fma_f32 v106, v106, s56, v34
    v_fma_f32 v107, v107, s56, v35
    s_waitcnt lgkmcnt(4)
    v_fma_f32 v108, v108, s56, v36
    buffer_load_dwordx4 v18, s[24:27], s44 offen offset:2048 lds
    s_add_u32 m0, s48, 24704
    s_mov_b32 s44, 616448
    v_mfma_f32_16x16x32_bf16 v[60:63], v[236:239], v[72:75], v[60:63]
    v_fma_f32 v109, v109, s56, v37
    v_fma_f32 v110, v110, s56, v38
    v_fma_f32 v111, v111, s56, v39
    s_waitcnt lgkmcnt(3)
    v_add_f32 v104, v104, v40
    v_add_f32 v105, v105, v41
    v_mfma_f32_16x16x32_bf16 v[48:51], v[184:187], v[76:79], v[48:51]
    ds_read_b128 v[72:75], v25 offset:1280
    v_add_f32 v106, v106, v42
    v_add_f32 v107, v107, v43
    s_waitcnt lgkmcnt(3)
    v_add_f32 v108, v108, v44
    v_add_f32 v109, v109, v45
    v_mfma_f32_16x16x32_bf16 v[52:55], v[200:203], v[76:79], v[52:55]
    v_add_f32 v110, v110, v46
    v_add_f32 v111, v111, v47
    v_fmac_f32 v88, v96, v104
    v_fmac_f32 v89, v97, v105
    v_fmac_f32 v90, v98, v106
    v_mfma_f32_16x16x32_bf16 v[56:59], v[216:219], v[76:79], v[56:59]
    buffer_load_dwordx4 v16, s[24:27], s44 offen offset:0 lds
    v_fmac_f32 v91, v99, v107
    v_fmac_f32 v92, v100, v108
    v_fmac_f32 v93, v101, v109
    v_fmac_f32 v94, v102, v110
    v_fmac_f32 v95, v103, v111
    v_mfma_f32_16x16x32_bf16 v[60:63], v[232:235], v[76:79], v[60:63]
    v_cvt_pk_bf16_f32 v120, v88, v89
    v_cvt_pk_bf16_f32 v121, v90, v91
    v_cvt_pk_bf16_f32 v122, v92, v93
    v_cvt_pk_bf16_f32 v123, v94, v95
    v_mfma_f32_16x16x32_bf16 v[48:51], v[180:183], v[80:83], v[48:51]
    ds_read_b128 v[76:79], v25 offset:1408
    v_permlane16_swap_b32 v120, v122
    v_permlane16_swap_b32 v121, v123
    v_mfma_f32_16x16x32_bf16 v[52:55], v[196:199], v[80:83], v[52:55]
    buffer_store_dwordx4 v[120:123], v14, s[36:39], 0 offen offset:0 sc1
    buffer_load_dwordx4 v17, s[24:27], s44 offen offset:1024 lds
    ds_read_b64_tr_b16 a[0:1], v20 offset:0
    ds_read_b64_tr_b16 a[2:3], v20 offset:3072
    ds_read_b64_tr_b16 a[4:5], v20 offset:8
    ds_read_b64_tr_b16 a[6:7], v20 offset:3080
    v_mfma_f32_16x16x32_bf16 v[56:59], v[212:215], v[80:83], v[56:59]
    ds_read_b64_tr_b16 a[8:9], v21 offset:0
    ds_read_b64_tr_b16 a[10:11], v21 offset:3072
    v_mfma_f32_16x16x32_bf16 v[60:63], v[228:231], v[80:83], v[60:63]
    ds_read_b64_tr_b16 a[12:13], v20 offset:12352
    ds_read_b64_tr_b16 a[14:15], v20 offset:15424
    v_mfma_f32_16x16x32_bf16 v[48:51], v[176:179], v[84:87], v[48:51]
    ds_read_b128 v[80:83], v25 offset:1536
    ds_read_b64_tr_b16 a[16:17], v20 offset:12360
    v_mfma_f32_16x16x32_bf16 v[52:55], v[192:195], v[84:87], v[52:55]
    ds_read_b64_tr_b16 a[18:19], v20 offset:15432
    ds_read_b64_tr_b16 a[20:21], v21 offset:12352
    v_mfma_f32_16x16x32_bf16 v[56:59], v[208:211], v[84:87], v[56:59]
    ds_read_b64_tr_b16 a[22:23], v21 offset:15424
    ds_read_b64_tr_b16 a[24:25], v20 offset:24704
    v_mfma_f32_16x16x32_bf16 v[60:63], v[224:227], v[84:87], v[60:63]
    ds_read_b64_tr_b16 a[26:27], v20 offset:27776
    ds_read_b64_tr_b16 a[28:29], v20 offset:24712
    s_waitcnt lgkmcnt(15)
    v_mfma_f32_16x16x32_bf16 v[48:51], v[172:175], v[64:67], v[48:51]
    ds_read_b128 v[84:87], v25 offset:1664
    ds_read_b64_tr_b16 a[30:31], v20 offset:27784
    v_mfma_f32_16x16x32_bf16 v[52:55], v[188:191], v[64:67], v[52:55]
    ds_read_b64_tr_b16 a[32:33], v21 offset:24704
    ds_read_b64_tr_b16 a[34:35], v21 offset:27776
    v_mfma_f32_16x16x32_bf16 v[56:59], v[204:207], v[64:67], v[56:59]
    v_mfma_f32_16x16x32_bf16 v[60:63], v[220:223], v[64:67], v[60:63]
    s_waitcnt lgkmcnt(15)
    v_mfma_f32_16x16x32_bf16 v[48:51], v[168:171], v[68:71], v[48:51]
    ds_read_b128 v[64:67], v25 offset:1792
    v_mfma_f32_16x16x32_bf16 v[52:55], v[184:187], v[68:71], v[52:55]
    buffer_load_dwordx4 v18, s[24:27], s44 offen offset:2048 lds
    s_add_u32 m0, s48, 37056
    s_mov_b32 s44, 704512
    v_mfma_f32_16x16x32_bf16 v[56:59], v[200:203], v[68:71], v[56:59]
    buffer_load_dwordx4 v16, s[24:27], s44 offen offset:0 lds
    v_mfma_f32_16x16x32_bf16 v[60:63], v[216:219], v[68:71], v[60:63]
    s_waitcnt lgkmcnt(15)
    v_mfma_f32_16x16x32_bf16 v[48:51], v[164:167], v[72:75], v[48:51]
    ds_read_b128 v[68:71], v25 offset:1920
    v_mfma_f32_16x16x32_bf16 v[52:55], v[180:183], v[72:75], v[52:55]
    v_mfma_f32_16x16x32_bf16 v[56:59], v[196:199], v[72:75], v[56:59]
    s_movk_i32 s51, 8192
    buffer_load_dwordx4 a[208:211], v13, s[36:39], s51 offen offset:0 sc1
    buffer_load_dwordx4 a[212:215], v13, s[36:39], s51 offen offset:128 sc1
    buffer_load_dwordx4 a[216:219], v13, s[36:39], s51 offen offset:2048 sc1
    buffer_load_dwordx4 a[220:223], v13, s[36:39], s51 offen offset:2176 sc1
    v_mfma_f32_16x16x32_bf16 v[60:63], v[212:215], v[72:75], v[60:63]
    buffer_load_dwordx4 v17, s[24:27], s44 offen offset:1024 lds
    s_waitcnt lgkmcnt(15)
    v_mfma_f32_16x16x32_bf16 v[48:51], v[160:163], v[76:79], v[48:51]
    s_cmp_lt_u32 s3, 2
    s_cbranch_scc1 L_oi_6
    s_waitcnt vmcnt(25)
    v_accvgpr_read_b32 v120, a227
    s_waitcnt vmcnt(24)
    v_accvgpr_read_b32 v121, a231
    s_waitcnt vmcnt(23)
    v_accvgpr_read_b32 v122, a235
    s_waitcnt vmcnt(22)
    v_accvgpr_read_b32 v123, a239
    s_waitcnt vmcnt(21)
    v_accvgpr_read_b32 v124, a243
    s_waitcnt vmcnt(20)
    v_accvgpr_read_b32 v125, a247
    v_bitop3_b32 v126, v120, v121, s6 bitop3:0x7e
    v_bitop3_b32 v126, v126, v122, s6 bitop3:0xf6
    v_bitop3_b32 v126, v126, v123, s6 bitop3:0xf6
    v_bitop3_b32 v126, v126, v124, s6 bitop3:0xf6
    v_bitop3_b32 v126, v126, v125, s6 bitop3:0xf6
    v_cmp_ne_u32 vcc, 0, v126
    s_cbranch_vccnz L_uhi_retry
L_uhi_ok:
    s_waitcnt vmcnt(24)
    ds_write2_b64 v26, a[224:225], a[228:229] offset0:0 offset1:1
    s_waitcnt vmcnt(23)
    ds_write_b64 v6, a[232:233]
    s_waitcnt vmcnt(24)
    ds_write2_b32 v6, a226, a230 offset0:2 offset1:3
    s_waitcnt vmcnt(21)
    ds_write2_b64 v27, a[236:237], a[240:241] offset0:0 offset1:1
    s_waitcnt vmcnt(20)
    ds_write_b64 v27, a[244:245] offset:16
    s_waitcnt vmcnt(21)
    ds_write2_b32 v27, a238, a242 offset0:6 offset1:7
L_oi_6:
    v_mfma_f32_16x16x32_bf16 v[52:55], v[176:179], v[76:79], v[52:55]
    v_mfma_f32_16x16x32_bf16 v[56:59], v[192:195], v[76:79], v[56:59]
    v_mfma_f32_16x16x32_bf16 v[60:63], v[208:211], v[76:79], v[60:63]
    s_waitcnt lgkmcnt(13)
    v_mfma_f32_16x16x32_bf16 v[48:51], v[156:159], v[80:83], v[48:51]
    buffer_load_dwordx4 v18, s[24:27], s44 offen offset:2048 lds
    s_add_u32 m0, s48, 49408
    s_mov_b32 s44, 792576
    v_mfma_f32_16x16x32_bf16 v[52:55], v[172:175], v[80:83], v[52:55]
    v_mfma_f32_16x16x32_bf16 v[56:59], v[188:191], v[80:83], v[56:59]
    v_mfma_f32_16x16x32_bf16 v[60:63], v[204:207], v[80:83], v[60:63]
    s_waitcnt lgkmcnt(5)
    v_mfma_f32_16x16x32_bf16 v[48:51], v[152:155], v[84:87], v[48:51]
    v_mfma_f32_16x16x32_bf16 v[52:55], v[168:171], v[84:87], v[52:55]
    v_mfma_f32_16x16x32_bf16 v[56:59], v[184:187], v[84:87], v[56:59]
    v_mfma_f32_16x16x32_bf16 v[60:63], v[200:203], v[84:87], v[60:63]
    buffer_load_dwordx4 v16, s[24:27], s44 offen offset:0 lds
    s_waitcnt vmcnt(21) lgkmcnt(0)
    s_barrier
    v_mfma_f32_16x16x32_bf16 v[48:51], v[148:151], v[64:67], v[48:51]
    ds_read_b128 v[72:75], v25 offset:2048
    ds_read_b64_tr_b16 a[36:37], v20 offset:37056
    v_mfma_f32_16x16x32_bf16 v[52:55], v[164:167], v[64:67], v[52:55]
    ds_read_b128 v[76:79], v25 offset:2176
    ds_read_b64_tr_b16 a[38:39], v20 offset:40128
    v_mfma_f32_16x16x32_bf16 v[56:59], v[180:183], v[64:67], v[56:59]
    ds_read_b128 v[80:83], v25 offset:2304
    s_waitcnt vmcnt(10)
    s_barrier
    s_cmp_lg_u32 s3, 0
    s_cbranch_scc1 L_ca_5
    s_movk_i32 s60, 0
    s_mov_b64 exec, 0xff
    buffer_atomic_add v5, v4, s[36:39], s60 offen sc1
    s_mov_b64 exec, -1
L_ca_5:
    v_mfma_f32_16x16x32_bf16 v[60:63], v[196:199], v[64:67], v[60:63]
    ds_read_b128 v[84:87], v25 offset:2432
    ds_read_b64_tr_b16 a[40:41], v20 offset:37064
    v_mfma_f32_16x16x32_bf16 v[48:51], v[144:147], v[68:71], v[48:51]
    ds_read_b128 v[64:67], v25 offset:2560
    ds_read_b64_tr_b16 a[42:43], v20 offset:40136
    v_mfma_f32_16x16x32_bf16 v[52:55], v[160:163], v[68:71], v[52:55]
    ds_read_b64_tr_b16 a[44:45], v21 offset:37056
    ds_read_b64_tr_b16 a[46:47], v21 offset:40128
    v_mfma_f32_16x16x32_bf16 v[56:59], v[176:179], v[68:71], v[56:59]
    ds_read_b64 v[112:113], v29 offset:2048
    ds_read_b64 v[114:115], v29 offset:2560
    v_mfma_f32_16x16x32_bf16 v[60:63], v[192:195], v[68:71], v[60:63]
    ds_read_b128 v[88:91], v28 offset:4096
    ds_read_b128 v[92:95], v28 offset:5120
    s_waitcnt lgkmcnt(14)
    v_mfma_f32_16x16x32_bf16 v[48:51], v[140:143], v[72:75], v[48:51]
    ds_read_b128 v[68:71], v25 offset:2688
    s_waitcnt vmcnt(6)
    v_accvgpr_read_b32 v120, a211
    v_mfma_f32_16x16x32_bf16 v[52:55], v[156:159], v[72:75], v[52:55]
    buffer_load_dwordx4 v17, s[24:27], s44 offen offset:1024 lds
    s_waitcnt vmcnt(6)
    v_accvgpr_read_b32 v121, a215
    s_waitcnt vmcnt(5)
    v_accvgpr_read_b32 v122, a219
    v_mfma_f32_16x16x32_bf16 v[56:59], v[172:175], v[72:75], v[56:59]
    s_waitcnt vmcnt(4)
    v_accvgpr_read_b32 v123, a223
    v_bitop3_b32 v126, v120, v121, s7 bitop3:0x7e
    v_mfma_f32_16x16x32_bf16 v[60:63], v[188:191], v[72:75], v[60:63]
    v_bitop3_b32 v127, v122, v123, s7 bitop3:0x7e
    v_or_b32 v126, v126, v127
    s_waitcnt lgkmcnt(13)
    v_mfma_f32_16x16x32_bf16 v[48:51], v[136:139], v[76:79], v[48:51]
    ds_read_b128 v[72:75], v25 offset:2816
    v_cmp_lt_u32 vcc, 7, v126
    s_cbranch_vccnz L_st1_retry
L_st1_ok:
    v_mfma_f32_16x16x32_bf16 v[52:55], v[152:155], v[76:79], v[52:55]
    buffer_load_dwordx4 v18, s[24:27], s44 offen offset:2048 lds
    s_add_u32 m0, s48, 65536
    s_mov_b32 s44, 880640
    s_xor_b32 s60, s7, s55
    v_bitop3_b32 v124, v120, v122, s60 bitop3:0x7e
    v_and_b32 v124, v124, v8
    v_or_b32 v9, v9, v124
    v_mfma_f32_16x16x32_bf16 v[56:59], v[168:171], v[76:79], v[56:59]
    s_waitcnt lgkmcnt(5)
    v_and_b32 v104, 0xffff0000, v113
    v_mfma_f32_16x16x32_bf16 v[60:63], v[184:187], v[76:79], v[60:63]
    v_lshlrev_b32 v105, 16, v113
    v_and_b32 v106, 0xffff0000, v112
    v_mfma_f32_16x16x32_bf16 v[48:51], v[132:135], v[80:83], v[48:51]
    ds_read_b128 v[76:79], v25 offset:2944
    v_lshlrev_b32 v107, 16, v112
    v_mfma_f32_16x16x32_bf16 v[52:55], v[148:151], v[80:83], v[52:55]
    s_waitcnt lgkmcnt(5)
    v_and_b32 v108, 0xffff0000, v115
    v_lshlrev_b32 v109, 16, v115
    v_mfma_f32_16x16x32_bf16 v[56:59], v[164:167], v[80:83], v[56:59]
    buffer_load_dwordx4 v16, s[24:27], s44 offen offset:0 lds
    v_and_b32 v110, 0xffff0000, v114
    v_lshlrev_b32 v111, 16, v114
    v_mfma_f32_16x16x32_bf16 v[60:63], v[180:183], v[80:83], v[60:63]
    v_accvgpr_read_b32 v96, a208
    v_accvgpr_read_b32 v97, a209
    v_mfma_f32_16x16x32_bf16 v[48:51], v[128:131], v[84:87], v[48:51]
    ds_read_b128 v[80:83], v25 offset:3072
    v_accvgpr_read_b32 v98, a212
    v_mfma_f32_16x16x32_bf16 v[52:55], v[144:147], v[84:87], v[52:55]
    v_accvgpr_read_b32 v99, a213
    v_accvgpr_read_b32 v100, a216
    v_mfma_f32_16x16x32_bf16 v[56:59], v[160:163], v[84:87], v[56:59]
    v_accvgpr_read_b32 v101, a217
    v_accvgpr_read_b32 v102, a220
    v_mfma_f32_16x16x32_bf16 v[60:63], v[176:179], v[84:87], v[60:63]
    v_accvgpr_read_b32 v103, a221
    v_and_b32 v116, 0xffff0000, v96
    v_mfma_f32_16x16x32_bf16 v[52:55], v[140:143], v[64:67], v[52:55]
    ds_read_b128 v[84:87], v25 offset:3200
    v_and_b32 v117, 0xffff0000, v97
    v_mfma_f32_16x16x32_bf16 v[56:59], v[156:159], v[64:67], v[56:59]
    buffer_load_dwordx4 v17, s[24:27], s44 offen offset:1024 lds
    v_and_b32 v118, 0xffff0000, v98
    v_and_b32 v119, 0xffff0000, v99
    v_mfma_f32_16x16x32_bf16 v[60:63], v[172:175], v[64:67], v[60:63]
    v_and_b32 v124, 0xffff0000, v100
    v_and_b32 v125, 0xffff0000, v101
    s_waitcnt lgkmcnt(4)
    v_mfma_f32_16x16x32_bf16 v[52:55], v[136:139], v[68:71], v[52:55]
    ds_read_b128 v[64:67], v25 offset:3328
    v_and_b32 v126, 0xffff0000, v102
    v_mfma_f32_16x16x32_bf16 v[56:59], v[152:155], v[68:71], v[56:59]
    v_and_b32 v127, 0xffff0000, v103
    v_lshlrev_b32 v96, 16, v96
    v_mfma_f32_16x16x32_bf16 v[60:63], v[168:171], v[68:71], v[60:63]
    v_lshlrev_b32 v97, 16, v97
    v_lshlrev_b32 v98, 16, v98
    s_waitcnt lgkmcnt(4)
    v_mfma_f32_16x16x32_bf16 v[52:55], v[132:135], v[72:75], v[52:55]
    ds_read_b128 v[68:71], v25 offset:3456
    v_lshlrev_b32 v99, 16, v99
    v_mfma_f32_16x16x32_bf16 v[56:59], v[148:151], v[72:75], v[56:59]
    buffer_load_dwordx4 v18, s[24:27], s44 offen offset:2048 lds
    s_add_u32 m0, s48, 77888
    s_mov_b32 s44, 968704
    v_lshlrev_b32 v100, 16, v100
    v_lshlrev_b32 v101, 16, v101
    v_mfma_f32_16x16x32_bf16 v[60:63], v[164:167], v[72:75], v[60:63]
    v_lshlrev_b32 v102, 16, v102
    v_lshlrev_b32 v103, 16, v103
    s_waitcnt lgkmcnt(4)
    v_mfma_f32_16x16x32_bf16 v[52:55], v[128:131], v[76:79], v[52:55]
    ds_read_b128 v[72:75], v25 offset:3584
    v_perm_b32 v88, v88, v88, s49
    v_mfma_f32_16x16x32_bf16 v[56:59], v[144:147], v[76:79], v[56:59]
    v_perm_b32 v89, v89, v89, s49
    v_perm_b32 v90, v90, v90, s49
    v_mfma_f32_16x16x32_bf16 v[60:63], v[160:163], v[76:79], v[60:63]
    v_perm_b32 v91, v91, v91, s49
    v_perm_b32 v92, v92, v92, s49
    s_waitcnt lgkmcnt(4)
    v_mfma_f32_16x16x32_bf16 v[56:59], v[140:143], v[80:83], v[56:59]
    ds_read_b128 v[76:79], v25 offset:3712
    v_perm_b32 v93, v93, v93, s49
    v_mfma_f32_16x16x32_bf16 v[60:63], v[156:159], v[80:83], v[60:63]
    buffer_load_dwordx4 v16, s[24:27], s44 offen offset:0 lds
    v_perm_b32 v94, v94, v94, s49
    v_perm_b32 v95, v95, v95, s49
    s_waitcnt lgkmcnt(4)
    v_mfma_f32_16x16x32_bf16 v[56:59], v[136:139], v[84:87], v[56:59]
    ds_read_b128 v[80:83], v25 offset:3840
    v_sub_f32 v96, v88, v96
    v_mfma_f32_16x16x32_bf16 v[60:63], v[152:155], v[84:87], v[60:63]
    v_sub_f32 v97, v89, v97
    v_sub_f32 v98, v90, v98
    s_waitcnt lgkmcnt(4)
    v_mfma_f32_16x16x32_bf16 v[56:59], v[132:135], v[64:67], v[56:59]
    ds_read_b128 v[84:87], v25 offset:3968
    v_sub_f32 v99, v91, v99
    v_mfma_f32_16x16x32_bf16 v[60:63], v[148:151], v[64:67], v[60:63]
    v_sub_f32 v100, v92, v100
    v_sub_f32 v101, v93, v101
    s_waitcnt lgkmcnt(4)
    v_mfma_f32_16x16x32_bf16 v[56:59], v[128:131], v[68:71], v[56:59]
    v_sub_f32 v102, v94, v102
    v_sub_f32 v103, v95, v103
    v_mfma_f32_16x16x32_bf16 v[60:63], v[144:147], v[68:71], v[60:63]
    buffer_load_dwordx4 v17, s[24:27], s44 offen offset:1024 lds
    v_mul_f32 v96, v96, v116
    v_mul_f32 v97, v97, v117
    s_waitcnt lgkmcnt(3)
    v_mfma_f32_16x16x32_bf16 v[60:63], v[140:143], v[72:75], v[60:63]
    v_mul_f32 v98, v98, v118
    v_mul_f32 v99, v99, v119
    s_waitcnt lgkmcnt(2)
    v_mfma_f32_16x16x32_bf16 v[60:63], v[136:139], v[76:79], v[60:63]
    v_mul_f32 v100, v100, v124
    v_mul_f32 v101, v101, v125
    s_waitcnt lgkmcnt(1)
    v_mfma_f32_16x16x32_bf16 v[60:63], v[132:135], v[80:83], v[60:63]
    v_mul_f32 v102, v102, v126
    v_mul_f32 v103, v103, v127
    s_waitcnt lgkmcnt(0)
    v_mfma_f32_16x16x32_bf16 v[60:63], v[128:131], v[84:87], v[60:63]
    v_cmp_ne_u32 vcc, 0, v9
    s_cmp_lg_u64 vcc, 0
    s_cselect_b32 s60, 1, 0
    v_mov_b32 v10, s60
    s_lshl_b32 s61, s3, 2
    s_add_u32 s61, s61, 161344
    v_mov_b32 v11, s61
    ds_write_b32 v11, v10
    ds_write_b128 v30, v[48:51] offset:0
    ds_write_b128 v30, v[52:55] offset:1024
    ds_write_b128 v30, v[56:59] offset:2048
    ds_write_b128 v30, v[60:63] offset:3072
    buffer_load_dwordx4 v18, s[24:27], s44 offen offset:2048 lds
    s_add_u32 m0, s48, 90240
    s_mov_b32 s44, 1056768
    s_waitcnt vmcnt(6) lgkmcnt(0)
    s_barrier
    ds_read_b128 v[48:51], v31 offset:0
    ds_read_b128 v[52:55], v31 offset:1024
    ds_read_b128 v[56:59], v31 offset:4096
    ds_read_b128 v[60:63], v31 offset:5120
    s_waitcnt lgkmcnt(3)
    v_fma_f32 v104, v104, s56, v48
    v_fma_f32 v105, v105, s56, v49
    v_fma_f32 v106, v106, s56, v50
    v_fma_f32 v107, v107, s56, v51
    s_waitcnt lgkmcnt(2)
    v_fma_f32 v108, v108, s56, v52
    v_fma_f32 v109, v109, s56, v53
    v_fma_f32 v110, v110, s56, v54
    v_fma_f32 v111, v111, s56, v55
    s_waitcnt lgkmcnt(1)
    v_add_f32 v104, v104, v56
    v_add_f32 v105, v105, v57
    v_add_f32 v106, v106, v58
    v_add_f32 v107, v107, v59
    s_waitcnt lgkmcnt(0)
    v_add_f32 v108, v108, v60
    v_add_f32 v109, v109, v61
    v_add_f32 v110, v110, v62
    buffer_load_dwordx4 v16, s[24:27], s44 offen offset:0 lds
    v_add_f32 v111, v111, v63
    v_fmac_f32 v88, v96, v104
    v_fmac_f32 v89, v97, v105
    v_fmac_f32 v90, v98, v106
    v_fmac_f32 v91, v99, v107
    v_fmac_f32 v92, v100, v108
    v_fmac_f32 v93, v101, v109
    v_fmac_f32 v94, v102, v110
    v_fmac_f32 v95, v103, v111
    v_cvt_pk_bf16_f32 v120, v88, v89
    v_cvt_pk_bf16_f32 v121, v90, v91
    v_cvt_pk_bf16_f32 v122, v92, v93
    v_cvt_pk_bf16_f32 v123, v94, v95
    s_nop 0
    v_permlane16_swap_b32 v120, v122
    v_permlane16_swap_b32 v121, v123
    buffer_store_dwordx4 v[120:123], v14, s[36:39], 0 offen offset:2048 sc1
    buffer_load_dwordx4 v17, s[24:27], s44 offen offset:1024 lds
    ds_read_b64_tr_b16 a[48:49], v20 offset:49408
    ds_read_b64_tr_b16 a[50:51], v20 offset:52480
    ds_read_b64_tr_b16 a[52:53], v20 offset:49416
    ds_read_b64_tr_b16 a[54:55], v20 offset:52488
    ds_read_b64_tr_b16 a[56:57], v21 offset:49408
    ds_read_b64_tr_b16 a[58:59], v21 offset:52480
    ds_read_b64_tr_b16 a[60:61], v15 offset:0
    ds_read_b64_tr_b16 a[62:63], v15 offset:3072
    ds_read_b64_tr_b16 a[64:65], v15 offset:8
    ds_read_b64_tr_b16 a[66:67], v15 offset:3080
    ds_read_b64_tr_b16 a[68:69], v19 offset:0
    buffer_load_dwordx4 v18, s[24:27], s44 offen offset:2048 lds
    s_add_u32 m0, s48, 102592
    s_mov_b32 s44, 1144832
    ds_read_b64_tr_b16 a[70:71], v19 offset:3072
    ds_read_b64_tr_b16 a[72:73], v15 offset:12352
    ds_read_b64_tr_b16 a[74:75], v15 offset:15424
    ds_read_b64_tr_b16 a[76:77], v15 offset:12360
    ds_read_b64_tr_b16 a[78:79], v15 offset:15432
    ds_read_b64_tr_b16 a[80:81], v19 offset:12352
    ds_read_b64_tr_b16 a[82:83], v19 offset:15424
    ds_read_b64_tr_b16 a[84:85], v15 offset:24704
    ds_read_b64_tr_b16 a[86:87], v15 offset:27776
    ds_read_b64_tr_b16 a[88:89], v15 offset:24712
    ds_read_b64_tr_b16 a[90:91], v15 offset:27784
    ds_read_b64_tr_b16 a[92:93], v19 offset:24704
    ds_read_b64_tr_b16 a[94:95], v19 offset:27776
    buffer_load_dwordx4 v16, s[24:27], s44 offen offset:0 lds
    ds_read_b64_tr_b16 a[96:97], v15 offset:37056
    ds_read_b64_tr_b16 a[98:99], v15 offset:40128
    ds_read_b64_tr_b16 a[100:101], v15 offset:37064
    ds_read_b64_tr_b16 a[102:103], v15 offset:40136
    ds_read_b64_tr_b16 a[104:105], v19 offset:37056
    ds_read_b64_tr_b16 a[106:107], v19 offset:40128
    ds_read_b64_tr_b16 a[108:109], v15 offset:49408
    ds_read_b64_tr_b16 a[110:111], v15 offset:52480
    ds_read_b64_tr_b16 a[112:113], v15 offset:49416
    ds_read_b64_tr_b16 a[114:115], v15 offset:52488
    ds_read_b64_tr_b16 a[116:117], v19 offset:49408
    ds_read_b64_tr_b16 a[118:119], v19 offset:52480
    s_or_b32 s60, s2, s3
    s_cmp_lg_u32 s60, 0
    s_cbranch_scc1 L_ep_7
    v_mov_b32 v12, s6
    v_mov_b32 v13, 0
    s_mov_b64 exec, 1
    buffer_store_dword v12, v13, s[36:39], 0 offen sc1
    s_mov_b64 exec, -1
L_ep_7:
    buffer_load_dwordx4 v17, s[24:27], s44 offen offset:1024 lds
    v_mov_b32 v8, 161344
    ds_read_b128 v[8:11], v8
    s_waitcnt lgkmcnt(0)
    v_or3_b32 v8, v8, v9, v10
    v_or_b32 v8, v8, v11
    s_nop 0
    v_readfirstlane_b32 s58, v8
    s_xor_b32 s58, s58, 1
    s_lshl_b32 s56, s65, 20
    s_lshl_b32 s45, s3, 12
    s_lshl_b32 s47, s3, 13
    s_lshl_b32 s57, s3, 14
    s_movk_i32 s52, 4096
    s_movk_i32 s53, 12288
    v_lshrrev_b32 v6, 3, v1
    v_and_b32 v7, 7, v1
    v_lshlrev_b32 v8, 1, v3
    v_xor_b32 v8, v7, v8
    v_lshlrev_b32 v8, 4, v8
    v_lshl_add_u32 v8, v6, 12, v8
    buffer_load_dwordx4 v18, s[24:27], s44 offen offset:2048 lds
    s_lshl_b32 s60, s4, 8
    s_lshl_b32 s61, s65, 7
    s_add_u32 s60, s60, s61
    s_lshl_b32 s61, s3, 17
    s_add_u32 s60, s60, s61
    s_add_u32 s60, s60, 9437184
    v_add_u32 v24, s60, v8
    s_add_u32 s60, s60, 31744
    v_add_u32 v25, s60, v8
    s_add_u32 s60, s60, 31744
    v_add_u32 v26, s60, v8
    s_add_u32 s60, s60, 31744
    v_add_u32 v27, s60, v8
    s_add_u32 s60, s60, 31744
    v_bfe_u32 v8, v1, 2, 2
    v_lshl_add_u32 v9, v3, 2, v8
    v_bfe_u32 v10, v9, 1, 2
    v_and_b32 v11, 3, v1
    v_lshlrev_b32 v11, 3, v11
    v_lshl_add_u32 v11, v9, 7, v11
    v_lshl_add_u32 v28, v10, 5, v11
    v_xor_b32 v29, 32, v28
    v_xor_b32 v30, 64, v28
    v_xor_b32 v31, 96, v28
    v_bfe_u32 v10, v1, 4, 1
    v_lshlrev_b32 v10, 2, v10
    v_xor_b32 v10, v7, v10
    v_lshlrev_b32 v10, 4, v10
    v_lshl_add_u32 v10, v6, 10, v10
    s_mul_i32 s60, s3, 360448
    s_and_b32 s61, s5, 7
    s_lshl_b32 s61, s61, 7
    s_add_u32 s60, s60, s61
    v_add_u32 v240, s60, v10
    s_add_u32 s60, s60, 7168
    v_add_u32 v241, s60, v10
    s_add_u32 s60, s60, 7168
    v_add_u32 v242, s60, v10
    s_add_u32 s60, s60, 7168
    v_add_u32 v243, s60, v10
    s_add_u32 s60, s60, 7168
    v_lshrrev_b32 v10, 1, v3
    v_lshl_add_u32 v10, v10, 3, v8
    v_lshlrev_b32 v10, 7, v10
    v_and_b32 v11, 1, v3
    v_lshl_add_u32 v10, v11, 5, v10
    v_and_b32 v11, 1, v1
    v_lshl_add_u32 v10, v11, 4, v10
    v_bfe_u32 v11, v1, 1, 1
    v_lshl_add_u32 v10, v11, 3, v10
    v_bfe_u32 v11, v1, 3, 1
    v_lshl_add_u32 v10, v11, 6, v10
    s_lshl_b32 s60, s3, 5
    v_xor_b32 v10, s60, v10
    s_lshl_b32 s60, s3, 13
    s_add_u32 s61, s60, 98304
    v_add_u32 v244, s61, v10
    v_xor_b32 v245, 64, v244
    s_lshl_b32 s60, s60, 1
    v_add_u32 v246, s60, v10
    v_xor_b32 v247, 64, v246
    v_lshrrev_b32 v8, 5, v1
    v_bfe_u32 v9, v1, 4, 1
    s_mul_i32 s60, s3, 3
    s_mul_i32 s61, s64, 12
    s_add_u32 s60, s60, s61
    s_lshl_b32 s61, s4, 3
    s_lshl_b32 s62, s65, 2
    s_add_u32 s61, s61, s62
    s_mul_i32 s61, s61, 44032
    s_add_u32 s61, s61, 11534336
    v_lshlrev_b32 v10, 8, v8
    v_lshl_add_u32 v10, v2, 4, v10
    v_add_u32 v10, s61, v10
    v_add_u32 v11, s60, v9
    v_lshl_add_u32 v248, v11, 9, v10
    v_mov_b32 v12, 0x80000000
    v_cmp_gt_u32 vcc, 172, v11
    s_nop 1
    v_cndmask_b32 v248, v12, v248, vcc
    v_add_u32 v249, 88064, v248
    s_add_u32 s60, s60, 2
    v_mul_u32_u24 v11, 88064, v9
    v_add_u32 v250, v11, v10
    s_lshl_b32 s61, s60, 9
    s_cmp_lt_u32 s60, 172
    s_cselect_b32 s61, s61, 0x80000000
    v_add_u32 v250, s61, v250
    s_lshl_b32 s60, s4, 11
    s_lshl_b32 s61, s65, 10
    s_add_u32 s60, s60, s61
    s_add_u32 s60, s60, 65536
    v_lshl_add_u32 v251, v2, 4, s60
    s_lshl_b32 s60, s55, 11
    s_add_u32 s60, s60, 32768
    v_lshl_add_u32 v252, v2, 7, s60
    s_lshl_b32 s86, s4, 7
    s_add_u32 s86, s86, 24576
    s_mov_b32 s101, 0x55
    s_cmp_eq_u32 s3, 1
    s_cselect_b32 s101, 0x5540, s101
    s_cmp_eq_u32 s3, 2
    s_cselect_b32 s101, 0x154000, s101
    s_cmp_eq_u32 s3, 3
    s_cselect_b32 s101, 0x15400000, s101
    s_lshr_b32 s60, s5, 4
    s_lshl_b32 s101, s101, s60
    s_lshr_b32 s60, s5, 3
    s_lshl_b32 s60, s60, 1
    s_lshl_b32 s61, s4, 3
    s_add_u32 s60, s60, s61
    s_mul_i32 s61, s60, 44032
    s_mul_i32 s62, s3, 22528
    s_add_u32 s61, s61, s62
    s_add_u32 s87, s61, 11534336
    s_movk_i32 s88, 16384
    s_movk_i32 s95, 20480
    s_lshl_b32 s89, s60, 4
    s_and_b32 s61, s5, 7
    s_lshl_b32 s61, s61, 6
    s_lshl_b32 s62, s3, 4
    s_add_u32 s90, s61, s62
    s_xor_b32 s60, s3, 0
    s_mul_i32 s60, s60, 6144
    s_add_u32 s91, s60, 65536
    s_xor_b32 s60, s3, 1
    s_mul_i32 s60, s60, 6144
    s_add_u32 s92, s60, 65536
    s_xor_b32 s60, s3, 2
    s_mul_i32 s60, s60, 6144
    s_add_u32 s93, s60, 67584
    s_xor_b32 s60, s3, 3
    s_mul_i32 s60, s60, 6144
    s_add_u32 s94, s60, 69632
    s_movk_i32 s51, 0
    buffer_load_dword v253, v252, s[36:39], s51 offen sc1
    s_waitcnt vmcnt(6) lgkmcnt(0)
    s_barrier
    s_add_u32 m0, s48, 131072
    s_mov_b32 s44, 1320960
    buffer_load_dwordx4 v16, s[24:27], s44 offen offset:0 lds
    buffer_load_dwordx4 v17, s[24:27], s44 offen offset:1024 lds
    s_cmp_lg_u32 s3, 0
    s_cbranch_scc1 L_ca_8
    s_movk_i32 s60, 16384
    s_mov_b64 exec, 0xff
    buffer_atomic_add v5, v4, s[36:39], s60 offen sc1
    s_mov_b64 exec, -1
L_ca_8:
    s_cmp_eq_u32 s64, 15
    s_cbranch_scc1 L_stats
    v_mov_b32 v172, 0x3f803f80
    v_mov_b32 v173, 0x3f803f80
    v_mov_b32 v174, 0x3f803f80
    v_mov_b32 v175, 0x3f803f80
    s_nop 1
    v_mfma_f32_16x16x32_bf16 v[160:163], a[0:3], v[172:175], 0
    v_mfma_f32_16x16x32_bf16 v[164:167], a[4:7], v[172:175], 0
    buffer_load_dwordx4 v18, s[24:27], s44 offen offset:2048 lds
    v_mfma_f32_16x16x32_bf16 v[168:171], a[8:11], v[172:175], 0
    v_mfma_f32_16x16x32_bf16 v[160:163], a[12:15], v[172:175], v[160:163]
    v_mfma_f32_16x16x32_bf16 v[164:167], a[16:19], v[172:175], v[164:167]
    v_mfma_f32_16x16x32_bf16 v[168:171], a[20:23], v[172:175], v[168:171]
    v_mfma_f32_16x16x32_bf16 v[160:163], a[24:27], v[172:175], v[160:163]
    v_mfma_f32_16x16x32_bf16 v[164:167], a[28:31], v[172:175], v[164:167]
    v_mfma_f32_16x16x32_bf16 v[168:171], a[32:35], v[172:175], v[168:171]
    v_mfma_f32_16x16x32_bf16 v[160:163], a[36:39], v[172:175], v[160:163]
    v_mfma_f32_16x16x32_bf16 v[164:167], a[40:43], v[172:175], v[164:167]
    v_mfma_f32_16x16x32_bf16 v[168:171], a[44:47], v[172:175], v[168:171]
    v_mfma_f32_16x16x32_bf16 v[160:163], a[48:51], v[172:175], v[160:163]
    v_mfma_f32_16x16x32_bf16 v[164:167], a[52:55], v[172:175], v[164:167]
    v_mfma_f32_16x16x32_bf16 v[168:171], a[56:59], v[172:175], v[168:171]
    v_mfma_f32_16x16x32_bf16 v[160:163], a[60:63], v[172:175], v[160:163]
    v_mfma_f32_16x16x32_bf16 v[164:167], a[64:67], v[172:175], v[164:167]
    v_mfma_f32_16x16x32_bf16 v[168:171], a[68:71], v[172:175], v[168:171]
    v_mfma_f32_16x16x32_bf16 v[160:163], a[72:75], v[172:175], v[160:163]
    v_mfma_f32_16x16x32_bf16 v[164:167], a[76:79], v[172:175], v[164:167]
    v_mfma_f32_16x16x32_bf16 v[168:171], a[80:83], v[172:175], v[168:171]
    s_waitcnt vmcnt(3)
    v_cmp_ne_u32 vcc, 16, v253
    s_cbranch_vccnz L_cnt0_retry
L_cnt0_ok:
    s_barrier
    s_add_u32 m0, s48, 114944
    s_mov_b32 s44, 1232896
    buffer_load_dwordx4 v16, s[24:27], s44 offen offset:0 lds
    buffer_load_dwordx4 v17, s[24:27], s44 offen offset:1024 lds
    s_add_u32 m0, s45, 0
    s_mov_b32 s44, 0
    buffer_load_dwordx4 v24, s[36:39], s44 offen offset:0 sc1 lds
    buffer_load_dwordx4 v25, s[36:39], s44 offen offset:1024 sc1 lds
    buffer_load_dwordx4 v26, s[36:39], s44 offen offset:2048 sc1 lds
    buffer_load_dwordx4 v27, s[36:39], s44 offen offset:3072 sc1 lds
    s_add_u32 m0, s45, 16384
    s_mov_b32 s44, 524288
    buffer_load_dwordx4 v24, s[36:39], s44 offen offset:0 sc1 lds
    buffer_load_dwordx4 v25, s[36:39], s44 offen offset:1024 sc1 lds
    buffer_load_dwordx4 v26, s[36:39], s44 offen offset:2048 sc1 lds
    buffer_load_dwordx4 v27, s[36:39], s44 offen offset:3072 sc1 lds
    s_add_u32 m0, s45, 32768
    s_mov_b32 s44, 1048576
    buffer_load_dwordx4 v24, s[36:39], s44 offen offset:0 sc1 lds
    buffer_load_dwordx4 v25, s[36:39], s44 offen offset:1024 sc1 lds
    buffer_load_dwordx4 v26, s[36:39], s44 offen offset:2048 sc1 lds
    buffer_load_dwordx4 v27, s[36:39], s44 offen offset:3072 sc1 lds
    s_add_u32 m0, s45, 49152
    s_mov_b32 s44, 1572864
    buffer_load_dwordx4 v24, s[36:39], s44 offen offset:0 sc1 lds
    buffer_load_dwordx4 v25, s[36:39], s44 offen offset:1024 sc1 lds
    buffer_load_dwordx4 v26, s[36:39], s44 offen offset:2048 sc1 lds
    buffer_load_dwordx4 v27, s[36:39], s44 offen offset:3072 sc1 lds
    s_add_u32 m0, s48, 114944
    s_mov_b32 s44, 1232896
    buffer_load_dwordx4 v18, s[24:27], s44 offen offset:2048 lds
    s_mul_i32 s60, s2, 1408
    s_min_u32 s60, s60, 350848
    v_add_u32 v10, s60, v0
    s_cmp_eq_u32 s3, 1
    s_cselect_b32 s66, s28, s24
    s_cselect_b32 s67, s29, s25
    s_cselect_b32 s60, 1, 0
    s_cmp_eq_u32 s3, 3
    s_cselect_b32 s60, 0, s60
    s_cmp_eq_u32 s60, 0
    s_cbranch_scc1 L_mp_9
    s_mov_b32 exec_lo, 0x0
    s_mov_b32 exec_hi, 0x0
    s_cmp_eq_u32 s3, 1
    s_cselect_b32 exec_lo, -1, exec_lo
    s_cselect_b32 exec_hi, 0xfff, exec_hi
    global_load_dword v255, v10, s[66:67]
    s_mov_b64 exec, -1
L_mp_9:
    ds_read_b64_tr_b16 a[120:121], v20 offset:0
    ds_read_b64_tr_b16 a[122:123], v20 offset:3072
    ds_read_b64_tr_b16 a[124:125], v20 offset:8
    ds_read_b64_tr_b16 a[126:127], v20 offset:3080
    ds_read_b64_tr_b16 a[128:129], v21 offset:0
    ds_read_b64_tr_b16 a[130:131], v21 offset:3072
    ds_read_b64_tr_b16 a[132:133], v20 offset:12352
    ds_read_b64_tr_b16 a[134:135], v20 offset:15424
    ds_read_b64_tr_b16 a[136:137], v20 offset:12360
    ds_read_b64_tr_b16 a[138:139], v20 offset:15432
    ds_read_b64_tr_b16 a[140:141], v21 offset:12352
    ds_read_b64_tr_b16 a[142:143], v21 offset:15424
    v_mfma_f32_16x16x32_bf16 v[160:163], a[84:87], v[172:175], v[160:163]
    v_mfma_f32_16x16x32_bf16 v[164:167], a[88:91], v[172:175], v[164:167]
    v_mfma_f32_16x16x32_bf16 v[168:171], a[92:95], v[172:175], v[168:171]
    v_mfma_f32_16x16x32_bf16 v[160:163], a[96:99], v[172:175], v[160:163]
    v_mfma_f32_16x16x32_bf16 v[164:167], a[100:103], v[172:175], v[164:167]
    v_mfma_f32_16x16x32_bf16 v[168:171], a[104:107], v[172:175], v[168:171]
    v_mfma_f32_16x16x32_bf16 v[160:163], a[108:111], v[172:175], v[160:163]
    v_mfma_f32_16x16x32_bf16 v[164:167], a[112:115], v[172:175], v[164:167]
    v_mfma_f32_16x16x32_bf16 v[168:171], a[116:119], v[172:175], v[168:171]
    s_waitcnt lgkmcnt(10)
    v_mfma_f32_16x16x32_bf16 v[160:163], a[120:123], v[172:175], v[160:163]
    s_waitcnt lgkmcnt(8)
    v_mfma_f32_16x16x32_bf16 v[164:167], a[124:127], v[172:175], v[164:167]
    s_waitcnt lgkmcnt(6)
    v_mfma_f32_16x16x32_bf16 v[168:171], a[128:131], v[172:175], v[168:171]
    s_waitcnt lgkmcnt(4)
    v_mfma_f32_16x16x32_bf16 v[160:163], a[132:135], v[172:175], v[160:163]
    s_waitcnt lgkmcnt(2)
    v_mfma_f32_16x16x32_bf16 v[164:167], a[136:139], v[172:175], v[164:167]
    s_waitcnt lgkmcnt(0)
    v_mfma_f32_16x16x32_bf16 v[168:171], a[140:143], v[172:175], v[168:171]
    s_waitcnt vmcnt(13)
    s_barrier
L_wa:
L_wb:
    ds_read_b64_tr_b16 v[128:129], v28 offset:0
    ds_read_b64_tr_b16 v[130:131], v28 offset:2048
    ds_read_b64_tr_b16 v[132:133], v29 offset:0
    ds_read_b64_tr_b16 v[134:135], v29 offset:2048
    ds_read_b64_tr_b16 v[136:137], v30 offset:0
    ds_read_b64_tr_b16 v[138:139], v30 offset:2048
    ds_read_b64_tr_b16 v[140:141], v31 offset:0
    ds_read_b64_tr_b16 v[142:143], v31 offset:2048
    s_waitcnt lgkmcnt(6)
    v_mfma_f32_16x16x32_bf16 v[32:35], a[0:3], v[128:131], 0
    ds_read_b64_tr_b16 v[144:145], v28 offset:4096
    ds_read_b64_tr_b16 a[144:145], v20 offset:24704
    v_mfma_f32_16x16x32_bf16 v[36:39], a[4:7], v[128:131], 0
    ds_read_b64_tr_b16 v[146:147], v28 offset:6144
    ds_read_b64_tr_b16 a[146:147], v20 offset:27776
    v_mfma_f32_16x16x32_bf16 v[40:43], a[8:11], v[128:131], 0
    ds_read_b64_tr_b16 v[148:149], v29 offset:4096
    ds_read_b64_tr_b16 a[148:149], v20 offset:24712
    s_waitcnt lgkmcnt(10)
    v_mfma_f32_16x16x32_bf16 v[44:47], a[0:3], v[132:135], 0
    ds_read_b64_tr_b16 v[150:151], v29 offset:6144
    ds_read_b64_tr_b16 a[150:151], v20 offset:27784
    v_mfma_f32_16x16x32_bf16 v[48:51], a[4:7], v[132:135], 0
    ds_read_b64_tr_b16 v[152:153], v30 offset:4096
    ds_read_b64_tr_b16 a[152:153], v21 offset:24704
    v_mfma_f32_16x16x32_bf16 v[52:55], a[8:11], v[132:135], 0
    ds_read_b64_tr_b16 v[154:155], v30 offset:6144
    ds_read_b64_tr_b16 a[154:155], v21 offset:27776
    s_waitcnt lgkmcnt(14)
    v_mfma_f32_16x16x32_bf16 v[56:59], a[0:3], v[136:139], 0
    ds_read_b64_tr_b16 v[156:157], v31 offset:4096
    ds_read_b64_tr_b16 a[156:157], v20 offset:37056
    v_mfma_f32_16x16x32_bf16 v[60:63], a[4:7], v[136:139], 0
    ds_read_b64_tr_b16 v[158:159], v31 offset:6144
    ds_read_b64_tr_b16 a[158:159], v20 offset:40128
    v_mfma_f32_16x16x32_bf16 v[64:67], a[8:11], v[136:139], 0
    ds_read_b64_tr_b16 a[160:161], v20 offset:37064
    ds_read_b64_tr_b16 a[162:163], v20 offset:40136
    s_waitcnt lgkmcnt(15)
    v_mfma_f32_16x16x32_bf16 v[68:71], a[0:3], v[140:143], 0
    ds_read_b64_tr_b16 a[164:165], v21 offset:37056
    ds_read_b64_tr_b16 a[166:167], v21 offset:40128
    v_mfma_f32_16x16x32_bf16 v[72:75], a[4:7], v[140:143], 0
    v_mfma_f32_16x16x32_bf16 v[76:79], a[8:11], v[140:143], 0
    s_waitcnt lgkmcnt(15)
    v_mfma_f32_16x16x32_bf16 v[32:35], a[12:15], v[144:147], v[32:35]
    ds_read_b64_tr_b16 v[128:129], v28 offset:8192
    v_mfma_f32_16x16x32_bf16 v[36:39], a[16:19], v[144:147], v[36:39]
    ds_read_b64_tr_b16 v[130:131], v28 offset:10240
    v_mfma_f32_16x16x32_bf16 v[40:43], a[20:23], v[144:147], v[40:43]
    ds_read_b64_tr_b16 v[132:133], v29 offset:8192
    s_waitcnt lgkmcnt(15)
    v_mfma_f32_16x16x32_bf16 v[44:47], a[12:15], v[148:151], v[44:47]
    ds_read_b64_tr_b16 v[134:135], v29 offset:10240
    v_mfma_f32_16x16x32_bf16 v[48:51], a[16:19], v[148:151], v[48:51]
    ds_read_b64_tr_b16 v[136:137], v30 offset:8192
    v_mfma_f32_16x16x32_bf16 v[52:55], a[20:23], v[148:151], v[52:55]
    ds_read_b64_tr_b16 v[138:139], v30 offset:10240
    s_waitcnt lgkmcnt(15)
    v_mfma_f32_16x16x32_bf16 v[56:59], a[12:15], v[152:155], v[56:59]
    ds_read_b64_tr_b16 v[140:141], v31 offset:8192
    v_mfma_f32_16x16x32_bf16 v[60:63], a[16:19], v[152:155], v[60:63]
    ds_read_b64_tr_b16 v[142:143], v31 offset:10240
    v_mfma_f32_16x16x32_bf16 v[64:67], a[20:23], v[152:155], v[64:67]
    s_waitcnt lgkmcnt(13)
    v_mfma_f32_16x16x32_bf16 v[68:71], a[12:15], v[156:159], v[68:71]
    v_mfma_f32_16x16x32_bf16 v[72:75], a[16:19], v[156:159], v[72:75]
    v_mfma_f32_16x16x32_bf16 v[76:79], a[20:23], v[156:159], v[76:79]
    s_waitcnt lgkmcnt(6)
    v_mfma_f32_16x16x32_bf16 v[32:35], a[24:27], v[128:131], v[32:35]
    ds_read_b64_tr_b16 v[144:145], v28 offset:12288
    v_mfma_f32_16x16x32_bf16 v[36:39], a[28:31], v[128:131], v[36:39]
    ds_read_b64_tr_b16 v[146:147], v28 offset:14336
    v_mfma_f32_16x16x32_bf16 v[40:43], a[32:35], v[128:131], v[40:43]
    ds_read_b64_tr_b16 v[148:149], v29 offset:12288
    s_waitcnt lgkmcnt(7)
    v_mfma_f32_16x16x32_bf16 v[44:47], a[24:27], v[132:135], v[44:47]
    ds_read_b64_tr_b16 v[150:151], v29 offset:14336
    v_mfma_f32_16x16x32_bf16 v[48:51], a[28:31], v[132:135], v[48:51]
    ds_read_b64_tr_b16 v[152:153], v30 offset:12288
    v_mfma_f32_16x16x32_bf16 v[52:55], a[32:35], v[132:135], v[52:55]
    ds_read_b64_tr_b16 v[154:155], v30 offset:14336
    s_waitcnt lgkmcnt(8)
    v_mfma_f32_16x16x32_bf16 v[56:59], a[24:27], v[136:139], v[56:59]
    ds_read_b64_tr_b16 v[156:157], v31 offset:12288
    v_mfma_f32_16x16x32_bf16 v[60:63], a[28:31], v[136:139], v[60:63]
    ds_read_b64_tr_b16 v[158:159], v31 offset:14336
    v_mfma_f32_16x16x32_bf16 v[64:67], a[32:35], v[136:139], v[64:67]
    s_waitcnt lgkmcnt(8)
    v_mfma_f32_16x16x32_bf16 v[68:71], a[24:27], v[140:143], v[68:71]
    v_mfma_f32_16x16x32_bf16 v[72:75], a[28:31], v[140:143], v[72:75]
    v_mfma_f32_16x16x32_bf16 v[76:79], a[32:35], v[140:143], v[76:79]
    s_waitcnt vmcnt(9)
    s_barrier
    s_waitcnt lgkmcnt(6)
    v_mfma_f32_16x16x32_bf16 v[32:35], a[36:39], v[144:147], v[32:35]
    ds_read_b64_tr_b16 v[128:129], v28 offset:16384
    v_mfma_f32_16x16x32_bf16 v[36:39], a[40:43], v[144:147], v[36:39]
    ds_read_b64_tr_b16 v[130:131], v28 offset:18432
    ds_read_b64_tr_b16 a[180:181], v22 offset:0
    v_mfma_f32_16x16x32_bf16 v[40:43], a[44:47], v[144:147], v[40:43]
    ds_read_b64_tr_b16 v[132:133], v29 offset:16384
    ds_read_b64_tr_b16 a[182:183], v22 offset:3072
    s_waitcnt lgkmcnt(9)
    v_mfma_f32_16x16x32_bf16 v[44:47], a[36:39], v[148:151], v[44:47]
    ds_read_b64_tr_b16 v[134:135], v29 offset:18432
    ds_read_b64_tr_b16 a[184:185], v22 offset:8
    v_mfma_f32_16x16x32_bf16 v[48:51], a[40:43], v[148:151], v[48:51]
    ds_read_b64_tr_b16 v[136:137], v30 offset:16384
    ds_read_b64_tr_b16 a[186:187], v22 offset:3080
    v_mfma_f32_16x16x32_bf16 v[52:55], a[44:47], v[148:151], v[52:55]
    ds_read_b64_tr_b16 v[138:139], v30 offset:18432
    ds_read_b64_tr_b16 a[188:189], v23 offset:0
    s_waitcnt lgkmcnt(13)
    v_mfma_f32_16x16x32_bf16 v[56:59], a[36:39], v[152:155], v[56:59]
    ds_read_b64_tr_b16 v[140:141], v31 offset:16384
    ds_read_b64_tr_b16 a[190:191], v23 offset:3072
    v_mfma_f32_16x16x32_bf16 v[60:63], a[40:43], v[152:155], v[60:63]
    ds_read_b64_tr_b16 v[142:143], v31 offset:18432
    v_mfma_f32_16x16x32_bf16 v[64:67], a[44:47], v[152:155], v[64:67]
    s_waitcnt lgkmcnt(14)
    v_mfma_f32_16x16x32_bf16 v[68:71], a[36:39], v[156:159], v[68:71]
    v_mfma_f32_16x16x32_bf16 v[72:75], a[40:43], v[156:159], v[72:75]
    v_mfma_f32_16x16x32_bf16 v[76:79], a[44:47], v[156:159], v[76:79]
    s_waitcnt lgkmcnt(12)
    v_mfma_f32_16x16x32_bf16 v[32:35], a[48:51], v[128:131], v[32:35]
    ds_read_b64_tr_b16 v[144:145], v28 offset:20480
    v_mfma_f32_16x16x32_bf16 v[36:39], a[52:55], v[128:131], v[36:39]
    ds_read_b64_tr_b16 v[146:147], v28 offset:22528
    v_mfma_f32_16x16x32_bf16 v[40:43], a[56:59], v[128:131], v[40:43]
    ds_read_b64_tr_b16 v[148:149], v29 offset:20480
    s_waitcnt lgkmcnt(11)
    v_mfma_f32_16x16x32_bf16 v[44:47], a[48:51], v[132:135], v[44:47]
    ds_read_b64_tr_b16 v[150:151], v29 offset:22528
    v_mfma_f32_16x16x32_bf16 v[48:51], a[52:55], v[132:135], v[48:51]
    ds_read_b64_tr_b16 v[152:153], v30 offset:20480
    v_mfma_f32_16x16x32_bf16 v[52:55], a[56:59], v[132:135], v[52:55]
    ds_read_b64_tr_b16 v[154:155], v30 offset:22528
    s_waitcnt lgkmcnt(10)
    v_mfma_f32_16x16x32_bf16 v[56:59], a[48:51], v[136:139], v[56:59]
    ds_read_b64_tr_b16 v[156:157], v31 offset:20480
    v_mfma_f32_16x16x32_bf16 v[60:63], a[52:55], v[136:139], v[60:63]
    ds_read_b64_tr_b16 v[158:159], v31 offset:22528
    v_mfma_f32_16x16x32_bf16 v[64:67], a[56:59], v[136:139], v[64:67]
    s_waitcnt lgkmcnt(8)
    v_mfma_f32_16x16x32_bf16 v[68:71], a[48:51], v[140:143], v[68:71]
    v_mfma_f32_16x16x32_bf16 v[72:75], a[52:55], v[140:143], v[72:75]
    v_mfma_f32_16x16x32_bf16 v[76:79], a[56:59], v[140:143], v[76:79]
    s_waitcnt vmcnt(0)
    s_barrier
    s_waitcnt lgkmcnt(6)
    v_mfma_f32_16x16x32_bf16 v[32:35], a[60:63], v[144:147], v[32:35]
    ds_read_b64_tr_b16 v[128:129], v28 offset:24576
    v_mfma_f32_16x16x32_bf16 v[36:39], a[64:67], v[144:147], v[36:39]
    ds_read_b64_tr_b16 v[130:131], v28 offset:26624
    ds_read_b64_tr_b16 a[168:169], v20 offset:49408
    v_mfma_f32_16x16x32_bf16 v[40:43], a[68:71], v[144:147], v[40:43]
    ds_read_b64_tr_b16 v[132:133], v29 offset:24576
    ds_read_b64_tr_b16 a[170:171], v20 offset:52480
    s_waitcnt lgkmcnt(9)
    v_mfma_f32_16x16x32_bf16 v[44:47], a[60:63], v[148:151], v[44:47]
    ds_read_b64_tr_b16 v[134:135], v29 offset:26624
    ds_read_b64_tr_b16 a[172:173], v20 offset:49416
    v_mfma_f32_16x16x32_bf16 v[48:51], a[64:67], v[148:151], v[48:51]
    ds_read_b64_tr_b16 v[136:137], v30 offset:24576
    ds_read_b64_tr_b16 a[174:175], v20 offset:52488
    v_mfma_f32_16x16x32_bf16 v[52:55], a[68:71], v[148:151], v[52:55]
    ds_read_b64_tr_b16 v[138:139], v30 offset:26624
    ds_read_b64_tr_b16 a[176:177], v21 offset:49408
    s_waitcnt lgkmcnt(13)
    v_mfma_f32_16x16x32_bf16 v[56:59], a[60:63], v[152:155], v[56:59]
    ds_read_b64_tr_b16 v[140:141], v31 offset:24576
    ds_read_b64_tr_b16 a[178:179], v21 offset:52480
    v_mfma_f32_16x16x32_bf16 v[60:63], a[64:67], v[152:155], v[60:63]
    ds_read_b64_tr_b16 v[142:143], v31 offset:26624
    s_movk_i32 s51, 16384
    buffer_load_dword v253, v252, s[36:39], s51 offen sc1
    v_mfma_f32_16x16x32_bf16 v[64:67], a[68:71], v[152:155], v[64:67]
    s_add_u32 m0, s47, 131072
    s_mov_b32 s44, 0
    buffer_load_dwordx4 v240, s[28:31], s44 offen offset:0 lds
    s_waitcnt lgkmcnt(14)
    v_mfma_f32_16x16x32_bf16 v[68:71], a[60:63], v[156:159], v[68:71]
    buffer_load_dwordx4 v241, s[28:31], s44 offen offset:1024 lds
    v_mfma_f32_16x16x32_bf16 v[72:75], a[64:67], v[156:159], v[72:75]
    buffer_load_dwordx4 v242, s[28:31], s44 offen offset:2048 lds
    v_mfma_f32_16x16x32_bf16 v[76:79], a[68:71], v[156:159], v[76:79]
    buffer_load_dwordx4 v243, s[28:31], s44 offen offset:3072 lds
    s_add_u32 m0, s47, 135168
    s_mov_b32 s44, 32768
    s_waitcnt lgkmcnt(12)
    v_mfma_f32_16x16x32_bf16 v[32:35], a[72:75], v[128:131], v[32:35]
    ds_read_b64_tr_b16 v[144:145], v28 offset:28672
    v_mfma_f32_16x16x32_bf16 v[36:39], a[76:79], v[128:131], v[36:39]
    ds_read_b64_tr_b16 v[146:147], v28 offset:30720
    v_mfma_f32_16x16x32_bf16 v[40:43], a[80:83], v[128:131], v[40:43]
    ds_read_b64_tr_b16 v[148:149], v29 offset:28672
    s_waitcnt lgkmcnt(11)
    v_mfma_f32_16x16x32_bf16 v[44:47], a[72:75], v[132:135], v[44:47]
    ds_read_b64_tr_b16 v[150:151], v29 offset:30720
    v_mfma_f32_16x16x32_bf16 v[48:51], a[76:79], v[132:135], v[48:51]
    ds_read_b64_tr_b16 v[152:153], v30 offset:28672
    v_mfma_f32_16x16x32_bf16 v[52:55], a[80:83], v[132:135], v[52:55]
    ds_read_b64_tr_b16 v[154:155], v30 offset:30720
    s_waitcnt lgkmcnt(10)
    v_mfma_f32_16x16x32_bf16 v[56:59], a[72:75], v[136:139], v[56:59]
    ds_read_b64_tr_b16 v[156:157], v31 offset:28672
    v_mfma_f32_16x16x32_bf16 v[60:63], a[76:79], v[136:139], v[60:63]
    ds_read_b64_tr_b16 v[158:159], v31 offset:30720
    v_mfma_f32_16x16x32_bf16 v[64:67], a[80:83], v[136:139], v[64:67]
    buffer_load_dwordx4 v240, s[28:31], s44 offen offset:0 lds
    s_waitcnt lgkmcnt(8)
    v_mfma_f32_16x16x32_bf16 v[68:71], a[72:75], v[140:143], v[68:71]
    buffer_load_dwordx4 v241, s[28:31], s44 offen offset:1024 lds
    v_mfma_f32_16x16x32_bf16 v[72:75], a[76:79], v[140:143], v[72:75]
    buffer_load_dwordx4 v242, s[28:31], s44 offen offset:2048 lds
    v_mfma_f32_16x16x32_bf16 v[76:79], a[80:83], v[140:143], v[76:79]
    s_barrier
    s_waitcnt lgkmcnt(6)
    v_mfma_f32_16x16x32_bf16 v[32:35], a[84:87], v[144:147], v[32:35]
    ds_read_b64_tr_b16 v[128:129], v28 offset:32768
    v_mfma_f32_16x16x32_bf16 v[36:39], a[88:91], v[144:147], v[36:39]
    ds_read_b64_tr_b16 v[130:131], v28 offset:34816
    s_waitcnt vmcnt(7)
    v_cmp_ne_u32 vcc, 16, v253
    s_cbranch_vccnz L_cnt1_retry
L_cnt1_ok:
    v_mfma_f32_16x16x32_bf16 v[40:43], a[92:95], v[144:147], v[40:43]
    ds_read_b64_tr_b16 v[132:133], v29 offset:32768
    s_waitcnt lgkmcnt(7)
    v_mfma_f32_16x16x32_bf16 v[44:47], a[84:87], v[148:151], v[44:47]
    ds_read_b64_tr_b16 v[134:135], v29 offset:34816
    v_mfma_f32_16x16x32_bf16 v[48:51], a[88:91], v[148:151], v[48:51]
    ds_read_b64_tr_b16 v[136:137], v30 offset:32768
    v_mfma_f32_16x16x32_bf16 v[52:55], a[92:95], v[148:151], v[52:55]
    ds_read_b64_tr_b16 v[138:139], v30 offset:34816
    s_waitcnt lgkmcnt(8)
    v_mfma_f32_16x16x32_bf16 v[56:59], a[84:87], v[152:155], v[56:59]
    ds_read_b64_tr_b16 v[140:141], v31 offset:32768
    v_mfma_f32_16x16x32_bf16 v[60:63], a[88:91], v[152:155], v[60:63]
    ds_read_b64_tr_b16 v[142:143], v31 offset:34816
    v_mfma_f32_16x16x32_bf16 v[64:67], a[92:95], v[152:155], v[64:67]
    buffer_load_dwordx4 v243, s[28:31], s44 offen offset:3072 lds
    s_add_u32 m0, s45, 65536
    s_mov_b32 s44, 2048
    s_waitcnt lgkmcnt(8)
    v_mfma_f32_16x16x32_bf16 v[68:71], a[84:87], v[156:159], v[68:71]
    buffer_load_dwordx4 v24, s[36:39], s44 offen offset:0 sc1 lds
    v_mfma_f32_16x16x32_bf16 v[72:75], a[88:91], v[156:159], v[72:75]
    buffer_load_dwordx4 v25, s[36:39], s44 offen offset:1024 sc1 lds
    v_mfma_f32_16x16x32_bf16 v[76:79], a[92:95], v[156:159], v[76:79]
    s_waitcnt lgkmcnt(6)
    v_mfma_f32_16x16x32_bf16 v[32:35], a[96:99], v[128:131], v[32:35]
    ds_read_b64_tr_b16 v[144:145], v28 offset:36864
    v_mfma_f32_16x16x32_bf16 v[36:39], a[100:103], v[128:131], v[36:39]
    ds_read_b64_tr_b16 v[146:147], v28 offset:38912
    v_mfma_f32_16x16x32_bf16 v[40:43], a[104:107], v[128:131], v[40:43]
    ds_read_b64_tr_b16 v[148:149], v29 offset:36864
    s_waitcnt lgkmcnt(7)
    v_mfma_f32_16x16x32_bf16 v[44:47], a[96:99], v[132:135], v[44:47]
    ds_read_b64_tr_b16 v[150:151], v29 offset:38912
    v_mfma_f32_16x16x32_bf16 v[48:51], a[100:103], v[132:135], v[48:51]
    ds_read_b64_tr_b16 v[152:153], v30 offset:36864
    v_mfma_f32_16x16x32_bf16 v[52:55], a[104:107], v[132:135], v[52:55]
    ds_read_b64_tr_b16 v[154:155], v30 offset:38912
    s_waitcnt lgkmcnt(8)
    v_mfma_f32_16x16x32_bf16 v[56:59], a[96:99], v[136:139], v[56:59]
    ds_read_b64_tr_b16 v[156:157], v31 offset:36864
    v_mfma_f32_16x16x32_bf16 v[60:63], a[100:103], v[136:139], v[60:63]
    ds_read_b64_tr_b16 v[158:159], v31 offset:38912
    v_mfma_f32_16x16x32_bf16 v[64:67], a[104:107], v[136:139], v[64:67]
    buffer_load_dwordx4 v26, s[36:39], s44 offen offset:2048 sc1 lds
    s_waitcnt lgkmcnt(8)
    v_mfma_f32_16x16x32_bf16 v[68:71], a[96:99], v[140:143], v[68:71]
    buffer_load_dwordx4 v27, s[36:39], s44 offen offset:3072 sc1 lds
    s_add_u32 m0, s45, 81920
    s_mov_b32 s44, 526336
    v_mfma_f32_16x16x32_bf16 v[72:75], a[100:103], v[140:143], v[72:75]
    buffer_load_dwordx4 v24, s[36:39], s44 offen offset:0 sc1 lds
    v_mfma_f32_16x16x32_bf16 v[76:79], a[104:107], v[140:143], v[76:79]
    buffer_load_dwordx4 v25, s[36:39], s44 offen offset:1024 sc1 lds
    s_waitcnt lgkmcnt(6)
    v_mfma_f32_16x16x32_bf16 v[32:35], a[108:111], v[144:147], v[32:35]
    ds_read_b64_tr_b16 v[128:129], v28 offset:40960
    v_mfma_f32_16x16x32_bf16 v[36:39], a[112:115], v[144:147], v[36:39]
    ds_read_b64_tr_b16 v[130:131], v28 offset:43008
    v_mfma_f32_16x16x32_bf16 v[40:43], a[116:119], v[144:147], v[40:43]
    ds_read_b64_tr_b16 v[132:133], v29 offset:40960
    s_waitcnt lgkmcnt(7)
    v_mfma_f32_16x16x32_bf16 v[44:47], a[108:111], v[148:151], v[44:47]
    ds_read_b64_tr_b16 v[134:135], v29 offset:43008
    v_mfma_f32_16x16x32_bf16 v[48:51], a[112:115], v[148:151], v[48:51]
    ds_read_b64_tr_b16 v[136:137], v30 offset:40960
    v_mfma_f32_16x16x32_bf16 v[52:55], a[116:119], v[148:151], v[52:55]
    ds_read_b64_tr_b16 v[138:139], v30 offset:43008
    s_waitcnt lgkmcnt(8)
    v_mfma_f32_16x16x32_bf16 v[56:59], a[108:111], v[152:155], v[56:59]
    ds_read_b64_tr_b16 v[140:141], v31 offset:40960
    v_mfma_f32_16x16x32_bf16 v[60:63], a[112:115], v[152:155], v[60:63]
    ds_read_b64_tr_b16 v[142:143], v31 offset:43008
    v_mfma_f32_16x16x32_bf16 v[64:67], a[116:119], v[152:155], v[64:67]
    buffer_load_dwordx4 v26, s[36:39], s44 offen offset:2048 sc1 lds
    s_waitcnt lgkmcnt(8)
    v_mfma_f32_16x16x32_bf16 v[68:71], a[108:111], v[156:159], v[68:71]
    buffer_load_dwordx4 v27, s[36:39], s44 offen offset:3072 sc1 lds
    s_add_u32 m0, s45, 98304
    s_mov_b32 s44, 1050624
    v_mfma_f32_16x16x32_bf16 v[72:75], a[112:115], v[156:159], v[72:75]
    buffer_load_dwordx4 v24, s[36:39], s44 offen offset:0 sc1 lds
    v_mfma_f32_16x16x32_bf16 v[76:79], a[116:119], v[156:159], v[76:79]
    s_waitcnt lgkmcnt(6)
    v_mfma_f32_16x16x32_bf16 v[32:35], a[120:123], v[128:131], v[32:35]
    ds_read_b64_tr_b16 v[144:145], v28 offset:45056
    v_mfma_f32_16x16x32_bf16 v[36:39], a[124:127], v[128:131], v[36:39]
    ds_read_b64_tr_b16 v[146:147], v28 offset:47104
    v_mfma_f32_16x16x32_bf16 v[40:43], a[128:131], v[128:131], v[40:43]
    ds_read_b64_tr_b16 v[148:149], v29 offset:45056
    s_waitcnt lgkmcnt(7)
    v_mfma_f32_16x16x32_bf16 v[44:47], a[120:123], v[132:135], v[44:47]
    ds_read_b64_tr_b16 v[150:151], v29 offset:47104
    v_mfma_f32_16x16x32_bf16 v[48:51], a[124:127], v[132:135], v[48:51]
    ds_read_b64_tr_b16 v[152:153], v30 offset:45056
    v_mfma_f32_16x16x32_bf16 v[52:55], a[128:131], v[132:135], v[52:55]
    ds_read_b64_tr_b16 v[154:155], v30 offset:47104
    s_waitcnt lgkmcnt(8)
    v_mfma_f32_16x16x32_bf16 v[56:59], a[120:123], v[136:139], v[56:59]
    ds_read_b64_tr_b16 v[156:157], v31 offset:45056
    v_mfma_f32_16x16x32_bf16 v[60:63], a[124:127], v[136:139], v[60:63]
    ds_read_b64_tr_b16 v[158:159], v31 offset:47104
    v_mfma_f32_16x16x32_bf16 v[64:67], a[128:131], v[136:139], v[64:67]
    buffer_load_dwordx4 v25, s[36:39], s44 offen offset:1024 sc1 lds
    s_waitcnt lgkmcnt(8)
    v_mfma_f32_16x16x32_bf16 v[68:71], a[120:123], v[140:143], v[68:71]
    buffer_load_dwordx4 v26, s[36:39], s44 offen offset:2048 sc1 lds
    v_mfma_f32_16x16x32_bf16 v[72:75], a[124:127], v[140:143], v[72:75]
    buffer_load_dwordx4 v27, s[36:39], s44 offen offset:3072 sc1 lds
    s_add_u32 m0, s45, 114688
    s_mov_b32 s44, 1574912
    v_mfma_f32_16x16x32_bf16 v[76:79], a[128:131], v[140:143], v[76:79]
    s_barrier
    s_waitcnt lgkmcnt(6)
    v_mfma_f32_16x16x32_bf16 v[32:35], a[132:135], v[144:147], v[32:35]
    ds_read_b64_tr_b16 v[128:129], v28 offset:49152
    v_mfma_f32_16x16x32_bf16 v[36:39], a[136:139], v[144:147], v[36:39]
    ds_read_b64_tr_b16 v[130:131], v28 offset:51200
    v_mfma_f32_16x16x32_bf16 v[40:43], a[140:143], v[144:147], v[40:43]
    ds_read_b64_tr_b16 v[132:133], v29 offset:49152
    s_waitcnt lgkmcnt(7)
    v_mfma_f32_16x16x32_bf16 v[44:47], a[132:135], v[148:151], v[44:47]
    ds_read_b64_tr_b16 v[134:135], v29 offset:51200
    v_mfma_f32_16x16x32_bf16 v[48:51], a[136:139], v[148:151], v[48:51]
    ds_read_b64_tr_b16 v[136:137], v30 offset:49152
    v_mfma_f32_16x16x32_bf16 v[52:55], a[140:143], v[148:151], v[52:55]
    ds_read_b64_tr_b16 v[138:139], v30 offset:51200
    s_waitcnt lgkmcnt(8)
    v_mfma_f32_16x16x32_bf16 v[56:59], a[132:135], v[152:155], v[56:59]
    ds_read_b64_tr_b16 v[140:141], v31 offset:49152
    v_mfma_f32_16x16x32_bf16 v[60:63], a[136:139], v[152:155], v[60:63]
    ds_read_b64_tr_b16 v[142:143], v31 offset:51200
    v_mfma_f32_16x16x32_bf16 v[64:67], a[140:143], v[152:155], v[64:67]
    buffer_load_dwordx4 v24, s[36:39], s44 offen offset:0 sc1 lds
    s_waitcnt lgkmcnt(8)
    v_mfma_f32_16x16x32_bf16 v[68:71], a[132:135], v[156:159], v[68:71]
    buffer_load_dwordx4 v25, s[36:39], s44 offen offset:1024 sc1 lds
    v_mfma_f32_16x16x32_bf16 v[72:75], a[136:139], v[156:159], v[72:75]
    buffer_load_dwordx4 v26, s[36:39], s44 offen offset:2048 sc1 lds
    v_mfma_f32_16x16x32_bf16 v[76:79], a[140:143], v[156:159], v[76:79]
    buffer_load_dwordx4 v27, s[36:39], s44 offen offset:3072 sc1 lds
    s_waitcnt lgkmcnt(6)
    v_mfma_f32_16x16x32_bf16 v[32:35], a[144:147], v[128:131], v[32:35]
    ds_read_b64_tr_b16 v[144:145], v28 offset:53248
    v_mfma_f32_16x16x32_bf16 v[36:39], a[148:151], v[128:131], v[36:39]
    ds_read_b64_tr_b16 v[146:147], v28 offset:55296
    v_mfma_f32_16x16x32_bf16 v[40:43], a[152:155], v[128:131], v[40:43]
    ds_read_b64_tr_b16 v[148:149], v29 offset:53248
    s_waitcnt lgkmcnt(7)
    v_mfma_f32_16x16x32_bf16 v[44:47], a[144:147], v[132:135], v[44:47]
    ds_read_b64_tr_b16 v[150:151], v29 offset:55296
    v_mfma_f32_16x16x32_bf16 v[48:51], a[148:151], v[132:135], v[48:51]
    ds_read_b64_tr_b16 v[152:153], v30 offset:53248
    v_mfma_f32_16x16x32_bf16 v[52:55], a[152:155], v[132:135], v[52:55]
    ds_read_b64_tr_b16 v[154:155], v30 offset:55296
    s_waitcnt lgkmcnt(8)
    v_mfma_f32_16x16x32_bf16 v[56:59], a[144:147], v[136:139], v[56:59]
    ds_read_b64_tr_b16 v[156:157], v31 offset:53248
    v_mfma_f32_16x16x32_bf16 v[60:63], a[148:151], v[136:139], v[60:63]
    ds_read_b64_tr_b16 v[158:159], v31 offset:55296
    v_mfma_f32_16x16x32_bf16 v[64:67], a[152:155], v[136:139], v[64:67]
    s_waitcnt lgkmcnt(8)
    v_mfma_f32_16x16x32_bf16 v[68:71], a[144:147], v[140:143], v[68:71]
    v_mfma_f32_16x16x32_bf16 v[72:75], a[148:151], v[140:143], v[72:75]
    v_mfma_f32_16x16x32_bf16 v[76:79], a[152:155], v[140:143], v[76:79]
    s_waitcnt lgkmcnt(6)
    v_mfma_f32_16x16x32_bf16 v[32:35], a[156:159], v[144:147], v[32:35]
    ds_read_b64_tr_b16 v[128:129], v28 offset:57344
    v_mfma_f32_16x16x32_bf16 v[36:39], a[160:163], v[144:147], v[36:39]
    ds_read_b64_tr_b16 v[130:131], v28 offset:59392
    s_mov_b32 s51, 2818048
    buffer_load_dword v255, v248, s[36:39], s51 offen
    v_mfma_f32_16x16x32_bf16 v[40:43], a[164:167], v[144:147], v[40:43]
    ds_read_b64_tr_b16 v[132:133], v29 offset:57344
    s_mov_b32 s51, 2818048
    buffer_load_dword v255, v249, s[36:39], s51 offen
    s_waitcnt lgkmcnt(7)
    v_mfma_f32_16x16x32_bf16 v[44:47], a[156:159], v[148:151], v[44:47]
    ds_read_b64_tr_b16 v[134:135], v29 offset:59392
    s_mov_b32 s51, 2818048
    buffer_load_dword v255, v250, s[36:39], s51 offen
    v_mfma_f32_16x16x32_bf16 v[48:51], a[160:163], v[148:151], v[48:51]
    ds_read_b64_tr_b16 v[136:137], v30 offset:57344
    v_mfma_f32_16x16x32_bf16 v[52:55], a[164:167], v[148:151], v[52:55]
    ds_read_b64_tr_b16 v[138:139], v30 offset:59392
    s_waitcnt lgkmcnt(8)
    v_mfma_f32_16x16x32_bf16 v[56:59], a[156:159], v[152:155], v[56:59]
    ds_read_b64_tr_b16 v[140:141], v31 offset:57344
    v_mfma_f32_16x16x32_bf16 v[60:63], a[160:163], v[152:155], v[60:63]
    ds_read_b64_tr_b16 v[142:143], v31 offset:59392
    v_mfma_f32_16x16x32_bf16 v[64:67], a[164:167], v[152:155], v[64:67]
    s_movk_i32 s51, 0
    buffer_load_dwordx4 v[176:179], v251, s[36:39], s51 offen offset:0 sc1
    buffer_load_dwordx4 v[180:183], v251, s[36:39], s51 offen offset:256 sc1
    buffer_load_dwordx4 v[184:187], v251, s[36:39], s51 offen offset:512 sc1
    buffer_load_dwordx4 v[188:191], v251, s[36:39], s51 offen offset:768 sc1
    s_waitcnt lgkmcnt(8)
    v_mfma_f32_16x16x32_bf16 v[68:71], a[156:159], v[156:159], v[68:71]
    v_mfma_f32_16x16x32_bf16 v[72:75], a[160:163], v[156:159], v[72:75]
    v_mfma_f32_16x16x32_bf16 v[76:79], a[164:167], v[156:159], v[76:79]
    s_waitcnt lgkmcnt(6)
    v_mfma_f32_16x16x32_bf16 v[32:35], a[168:171], v[128:131], v[32:35]
    ds_read_b64_tr_b16 v[144:145], v28 offset:61440
    v_mfma_f32_16x16x32_bf16 v[36:39], a[172:175], v[128:131], v[36:39]
    ds_read_b64_tr_b16 v[146:147], v28 offset:63488
    v_mfma_f32_16x16x32_bf16 v[40:43], a[176:179], v[128:131], v[40:43]
    ds_read_b64_tr_b16 v[148:149], v29 offset:61440
    s_waitcnt lgkmcnt(7)
    v_mfma_f32_16x16x32_bf16 v[44:47], a[168:171], v[132:135], v[44:47]
    ds_read_b64_tr_b16 v[150:151], v29 offset:63488
    v_mfma_f32_16x16x32_bf16 v[48:51], a[172:175], v[132:135], v[48:51]
    ds_read_b64_tr_b16 v[152:153], v30 offset:61440
    v_mfma_f32_16x16x32_bf16 v[52:55], a[176:179], v[132:135], v[52:55]
    ds_read_b64_tr_b16 v[154:155], v30 offset:63488
    s_waitcnt lgkmcnt(8)
    v_mfma_f32_16x16x32_bf16 v[56:59], a[168:171], v[136:139], v[56:59]
    ds_read_b64_tr_b16 v[156:157], v31 offset:61440
    v_mfma_f32_16x16x32_bf16 v[60:63], a[172:175], v[136:139], v[60:63]
    ds_read_b64_tr_b16 v[158:159], v31 offset:63488
    v_mfma_f32_16x16x32_bf16 v[64:67], a[176:179], v[136:139], v[64:67]
    s_waitcnt lgkmcnt(8)
    v_mfma_f32_16x16x32_bf16 v[68:71], a[168:171], v[140:143], v[68:71]
    v_mfma_f32_16x16x32_bf16 v[72:75], a[172:175], v[140:143], v[72:75]
    v_mfma_f32_16x16x32_bf16 v[76:79], a[176:179], v[140:143], v[76:79]
    s_waitcnt vmcnt(19)
    s_barrier
    v_add_u32 v28, 65536, v28
    v_add_u32 v29, 65536, v29
    v_add_u32 v30, 65536, v30
    v_add_u32 v31, 65536, v31
    s_waitcnt lgkmcnt(6)
    v_mfma_f32_16x16x32_bf16 v[32:35], a[180:183], v[144:147], v[32:35]
    ds_read_b64_tr_b16 v[128:129], v28 offset:0
    v_mfma_f32_16x16x32_bf16 v[36:39], a[184:187], v[144:147], v[36:39]
    ds_read_b64_tr_b16 v[130:131], v28 offset:2048
    v_mfma_f32_16x16x32_bf16 v[40:43], a[188:191], v[144:147], v[40:43]
    ds_read_b64_tr_b16 v[132:133], v29 offset:0
    s_waitcnt lgkmcnt(7)
    v_mfma_f32_16x16x32_bf16 v[44:47], a[180:183], v[148:151], v[44:47]
    ds_read_b64_tr_b16 v[134:135], v29 offset:2048
    v_mfma_f32_16x16x32_bf16 v[48:51], a[184:187], v[148:151], v[48:51]
    ds_read_b64_tr_b16 v[136:137], v30 offset:0
    v_mfma_f32_16x16x32_bf16 v[52:55], a[188:191], v[148:151], v[52:55]
    ds_read_b64_tr_b16 v[138:139], v30 offset:2048
    s_waitcnt lgkmcnt(8)
    v_mfma_f32_16x16x32_bf16 v[56:59], a[180:183], v[152:155], v[56:59]
    ds_read_b64_tr_b16 v[140:141], v31 offset:0
    v_mfma_f32_16x16x32_bf16 v[60:63], a[184:187], v[152:155], v[60:63]
    ds_read_b64_tr_b16 v[142:143], v31 offset:2048
    v_mfma_f32_16x16x32_bf16 v[64:67], a[188:191], v[152:155], v[64:67]
    s_waitcnt lgkmcnt(8)
    v_mfma_f32_16x16x32_bf16 v[68:71], a[180:183], v[156:159], v[68:71]
    v_mfma_f32_16x16x32_bf16 v[72:75], a[184:187], v[156:159], v[72:75]
    v_mfma_f32_16x16x32_bf16 v[76:79], a[188:191], v[156:159], v[76:79]
    s_barrier
    v_mfma_f32_16x16x32_bf16 v[160:163], a[144:147], v[172:175], v[160:163]
    s_add_u32 m0, s57, 0
    s_mov_b32 s44, 65536
    buffer_load_dwordx4 v240, s[28:31], s44 offen offset:0 lds
    v_mfma_f32_16x16x32_bf16 v[164:167], a[148:151], v[172:175], v[164:167]
    buffer_load_dwordx4 v241, s[28:31], s44 offen offset:1024 lds
    v_mfma_f32_16x16x32_bf16 v[168:171], a[152:155], v[172:175], v[168:171]
    buffer_load_dwordx4 v242, s[28:31], s44 offen offset:2048 lds
    v_mfma_f32_16x16x32_bf16 v[160:163], a[156:159], v[172:175], v[160:163]
    buffer_load_dwordx4 v243, s[28:31], s44 offen offset:3072 lds
    s_add_u32 m0, s57, 4096
    s_mov_b32 s44, 98304
    v_mfma_f32_16x16x32_bf16 v[164:167], a[160:163], v[172:175], v[164:167]
    v_mfma_f32_16x16x32_bf16 v[168:171], a[164:167], v[172:175], v[168:171]
    v_mfma_f32_16x16x32_bf16 v[160:163], a[168:171], v[172:175], v[160:163]
    v_mfma_f32_16x16x32_bf16 v[164:167], a[172:175], v[172:175], v[164:167]
    buffer_load_dwordx4 v240, s[28:31], s44 offen offset:0 lds
    v_mfma_f32_16x16x32_bf16 v[168:171], a[176:179], v[172:175], v[168:171]
    v_mfma_f32_16x16x32_bf16 v[160:163], a[180:183], v[172:175], v[160:163]
    v_mfma_f32_16x16x32_bf16 v[164:167], a[184:187], v[172:175], v[164:167]
    buffer_load_dwordx4 v241, s[28:31], s44 offen offset:1024 lds
    v_mfma_f32_16x16x32_bf16 v[168:171], a[188:191], v[172:175], v[168:171]
    s_waitcnt vmcnt(8)
    v_bitop3_b32 v172, v178, v182, s6 bitop3:0x7e
    v_bitop3_b32 v173, v179, v183, s7 bitop3:0x7e
    s_waitcnt vmcnt(6)
    v_bitop3_b32 v174, v186, v190, s6 bitop3:0x7e
    v_bitop3_b32 v175, v187, v191, s7 bitop3:0x7e
    v_or3_b32 v254, v172, v173, v174
    v_or_b32 v254, v254, v175
    v_cmp_ne_u32 vcc, 0, v254
    s_cbranch_vccnz L_st2_0_retry
L_st2_0_ok:
    v_cmp_gt_u32 vcc, 32, v1
    s_nop 1
    v_cndmask_b32 v206, v181, v177, vcc
    v_cndmask_b32 v207, v189, v185, vcc
    v_rcp_f32 v204, v206
    buffer_load_dwordx4 v242, s[28:31], s44 offen offset:2048 lds
    v_rcp_f32 v205, v207
    v_mul_f32 v204, 0xbfb8aa3b, v204
    v_mul_f32 v205, 0xbfb8aa3b, v205
    v_pk_fma_f32 v[32:33], v[176:177], v[160:161], v[32:33] op_sel_hi:[0,1,1] neg_lo:[1,0,0] neg_hi:[1,0,0]
    v_pk_fma_f32 v[34:35], v[176:177], v[162:163], v[34:35] op_sel_hi:[0,1,1] neg_lo:[1,0,0] neg_hi:[1,0,0]
    v_pk_fma_f32 v[44:45], v[180:181], v[160:161], v[44:45] op_sel_hi:[0,1,1] neg_lo:[1,0,0] neg_hi:[1,0,0]
    v_pk_fma_f32 v[46:47], v[180:181], v[162:163], v[46:47] op_sel_hi:[0,1,1] neg_lo:[1,0,0] neg_hi:[1,0,0]
    s_nop 0
    v_permlane32_swap_b32 v32, v44
    v_permlane32_swap_b32 v33, v45
    buffer_load_dwordx4 v243, s[28:31], s44 offen offset:3072 lds
    s_add_u32 m0, s57, 8192
    s_mov_b32 s44, 294912
    v_permlane32_swap_b32 v34, v46
    v_permlane32_swap_b32 v35, v47
    v_pk_mul_f32 v[32:33], v[204:205], v[32:33] op_sel:[0,0] op_sel_hi:[0,1]
    v_pk_mul_f32 v[34:35], v[204:205], v[34:35] op_sel:[0,0] op_sel_hi:[0,1]
    v_exp_f32 v32, v32
    v_exp_f32 v33, v33
    v_exp_f32 v34, v34
    v_exp_f32 v35, v35
    v_pk_fma_f32 v[32:33], v[32:33], v[206:207], v[206:207] op_sel:[0,0,0] op_sel_hi:[1,0,0]
    buffer_load_dwordx4 v240, s[28:31], s44 offen offset:0 lds
    v_pk_fma_f32 v[34:35], v[34:35], v[206:207], v[206:207] op_sel:[0,0,0] op_sel_hi:[1,0,0]
    v_rcp_f32 v32, v32
    v_rcp_f32 v33, v33
    v_rcp_f32 v34, v34
    v_rcp_f32 v35, v35
    v_pk_mul_f32 v[44:45], v[44:45], v[32:33]
    v_pk_mul_f32 v[46:47], v[46:47], v[34:35]
    v_cvt_pk_bf16_f32 v192, v44, v45
    v_cvt_pk_bf16_f32 v193, v46, v47
    v_pk_fma_f32 v[36:37], v[176:177], v[164:165], v[36:37] op_sel_hi:[0,1,1] neg_lo:[1,0,0] neg_hi:[1,0,0]
    buffer_load_dwordx4 v241, s[28:31], s44 offen offset:1024 lds
    v_pk_fma_f32 v[38:39], v[176:177], v[166:167], v[38:39] op_sel_hi:[0,1,1] neg_lo:[1,0,0] neg_hi:[1,0,0]
    v_pk_fma_f32 v[48:49], v[180:181], v[164:165], v[48:49] op_sel_hi:[0,1,1] neg_lo:[1,0,0] neg_hi:[1,0,0]
    v_pk_fma_f32 v[50:51], v[180:181], v[166:167], v[50:51] op_sel_hi:[0,1,1] neg_lo:[1,0,0] neg_hi:[1,0,0]
    s_nop 0
    v_permlane32_swap_b32 v36, v48
    v_permlane32_swap_b32 v37, v49
    v_permlane32_swap_b32 v38, v50
    v_permlane32_swap_b32 v39, v51
    v_pk_mul_f32 v[36:37], v[204:205], v[36:37] op_sel:[0,0] op_sel_hi:[0,1]
    v_pk_mul_f32 v[38:39], v[204:205], v[38:39] op_sel:[0,0] op_sel_hi:[0,1]
    v_exp_f32 v36, v36
    buffer_load_dwordx4 v242, s[28:31], s44 offen offset:2048 lds
    v_exp_f32 v37, v37
    v_exp_f32 v38, v38
    v_exp_f32 v39, v39
    v_pk_fma_f32 v[36:37], v[36:37], v[206:207], v[206:207] op_sel:[0,0,0] op_sel_hi:[1,0,0]
    v_pk_fma_f32 v[38:39], v[38:39], v[206:207], v[206:207] op_sel:[0,0,0] op_sel_hi:[1,0,0]
    v_rcp_f32 v36, v36
    v_rcp_f32 v37, v37
    v_rcp_f32 v38, v38
    buffer_load_dwordx4 v243, s[28:31], s44 offen offset:3072 lds
    s_add_u32 m0, s57, 12288
    s_mov_b32 s44, 327680
    v_rcp_f32 v39, v39
    v_pk_mul_f32 v[48:49], v[48:49], v[36:37]
    v_pk_mul_f32 v[50:51], v[50:51], v[38:39]
    v_cvt_pk_bf16_f32 v194, v48, v49
    v_cvt_pk_bf16_f32 v195, v50, v51
    v_pk_fma_f32 v[40:41], v[176:177], v[168:169], v[40:41] op_sel_hi:[0,1,1] neg_lo:[1,0,0] neg_hi:[1,0,0]
    v_pk_fma_f32 v[42:43], v[176:177], v[170:171], v[42:43] op_sel_hi:[0,1,1] neg_lo:[1,0,0] neg_hi:[1,0,0]
    v_pk_fma_f32 v[52:53], v[180:181], v[168:169], v[52:53] op_sel_hi:[0,1,1] neg_lo:[1,0,0] neg_hi:[1,0,0]
    v_pk_fma_f32 v[54:55], v[180:181], v[170:171], v[54:55] op_sel_hi:[0,1,1] neg_lo:[1,0,0] neg_hi:[1,0,0]
    s_nop 0
    v_permlane32_swap_b32 v40, v52
    v_permlane32_swap_b32 v41, v53
    buffer_load_dwordx4 v240, s[28:31], s44 offen offset:0 lds
    v_permlane32_swap_b32 v42, v54
    v_permlane32_swap_b32 v43, v55
    v_pk_mul_f32 v[40:41], v[204:205], v[40:41] op_sel:[0,0] op_sel_hi:[0,1]
    v_pk_mul_f32 v[42:43], v[204:205], v[42:43] op_sel:[0,0] op_sel_hi:[0,1]
    v_exp_f32 v40, v40
    v_exp_f32 v41, v41
    v_exp_f32 v42, v42
    v_exp_f32 v43, v43
    buffer_load_dwordx4 v241, s[28:31], s44 offen offset:1024 lds
    v_pk_fma_f32 v[40:41], v[40:41], v[206:207], v[206:207] op_sel:[0,0,0] op_sel_hi:[1,0,0]
    v_pk_fma_f32 v[42:43], v[42:43], v[206:207], v[206:207] op_sel:[0,0,0] op_sel_hi:[1,0,0]
    v_rcp_f32 v40, v40
    v_rcp_f32 v41, v41
    v_rcp_f32 v42, v42
    v_rcp_f32 v43, v43
    v_pk_mul_f32 v[52:53], v[52:53], v[40:41]
    v_pk_mul_f32 v[54:55], v[54:55], v[42:43]
    v_cvt_pk_bf16_f32 v200, v52, v53
    buffer_load_dwordx4 v242, s[28:31], s44 offen offset:2048 lds
    v_cvt_pk_bf16_f32 v201, v54, v55
    v_pk_fma_f32 v[56:57], v[184:185], v[160:161], v[56:57] op_sel_hi:[0,1,1] neg_lo:[1,0,0] neg_hi:[1,0,0]
    v_pk_fma_f32 v[58:59], v[184:185], v[162:163], v[58:59] op_sel_hi:[0,1,1] neg_lo:[1,0,0] neg_hi:[1,0,0]
    v_pk_fma_f32 v[68:69], v[188:189], v[160:161], v[68:69] op_sel_hi:[0,1,1] neg_lo:[1,0,0] neg_hi:[1,0,0]
    v_pk_fma_f32 v[70:71], v[188:189], v[162:163], v[70:71] op_sel_hi:[0,1,1] neg_lo:[1,0,0] neg_hi:[1,0,0]
    s_nop 0
    v_permlane32_swap_b32 v56, v68
    v_permlane32_swap_b32 v57, v69
    v_permlane32_swap_b32 v58, v70
    v_permlane32_swap_b32 v59, v71
    v_pk_mul_f32 v[56:57], v[204:205], v[56:57] op_sel:[1,0] op_sel_hi:[1,1]
    buffer_load_dwordx4 v243, s[28:31], s44 offen offset:3072 lds
    v_pk_mul_f32 v[58:59], v[204:205], v[58:59] op_sel:[1,0] op_sel_hi:[1,1]
    v_exp_f32 v56, v56
    v_exp_f32 v57, v57
    v_exp_f32 v58, v58
    v_exp_f32 v59, v59
    v_pk_fma_f32 v[56:57], v[56:57], v[206:207], v[206:207] op_sel:[0,1,1] op_sel_hi:[1,1,1]
    v_pk_fma_f32 v[58:59], v[58:59], v[206:207], v[206:207] op_sel:[0,1,1] op_sel_hi:[1,1,1]
    v_rcp_f32 v56, v56
    v_rcp_f32 v57, v57
    v_rcp_f32 v58, v58
    v_rcp_f32 v59, v59
    v_pk_mul_f32 v[68:69], v[68:69], v[56:57]
    v_pk_mul_f32 v[70:71], v[70:71], v[58:59]
    v_cvt_pk_bf16_f32 v196, v68, v69
    v_cvt_pk_bf16_f32 v197, v70, v71
    v_pk_fma_f32 v[60:61], v[184:185], v[164:165], v[60:61] op_sel_hi:[0,1,1] neg_lo:[1,0,0] neg_hi:[1,0,0]
    v_pk_fma_f32 v[62:63], v[184:185], v[166:167], v[62:63] op_sel_hi:[0,1,1] neg_lo:[1,0,0] neg_hi:[1,0,0]
    v_pk_fma_f32 v[72:73], v[188:189], v[164:165], v[72:73] op_sel_hi:[0,1,1] neg_lo:[1,0,0] neg_hi:[1,0,0]
    v_pk_fma_f32 v[74:75], v[188:189], v[166:167], v[74:75] op_sel_hi:[0,1,1] neg_lo:[1,0,0] neg_hi:[1,0,0]
    s_nop 0
    v_permlane32_swap_b32 v60, v72
    v_permlane32_swap_b32 v61, v73
    v_permlane32_swap_b32 v62, v74
    v_permlane32_swap_b32 v63, v75
    v_pk_mul_f32 v[60:61], v[204:205], v[60:61] op_sel:[1,0] op_sel_hi:[1,1]
    v_pk_mul_f32 v[62:63], v[204:205], v[62:63] op_sel:[1,0] op_sel_hi:[1,1]
    v_exp_f32 v60, v60
    v_exp_f32 v61, v61
    v_exp_f32 v62, v62
    v_exp_f32 v63, v63
    v_pk_fma_f32 v[60:61], v[60:61], v[206:207], v[206:207] op_sel:[0,1,1] op_sel_hi:[1,1,1]
    v_pk_fma_f32 v[62:63], v[62:63], v[206:207], v[206:207] op_sel:[0,1,1] op_sel_hi:[1,1,1]
    v_rcp_f32 v60, v60
    v_rcp_f32 v61, v61
    v_rcp_f32 v62, v62
    v_rcp_f32 v63, v63
    v_pk_mul_f32 v[72:73], v[72:73], v[60:61]
    v_pk_mul_f32 v[74:75], v[74:75], v[62:63]
    v_cvt_pk_bf16_f32 v198, v72, v73
    v_cvt_pk_bf16_f32 v199, v74, v75
    v_pk_fma_f32 v[64:65], v[184:185], v[168:169], v[64:65] op_sel_hi:[0,1,1] neg_lo:[1,0,0] neg_hi:[1,0,0]
    v_pk_fma_f32 v[66:67], v[184:185], v[170:171], v[66:67] op_sel_hi:[0,1,1] neg_lo:[1,0,0] neg_hi:[1,0,0]
    v_pk_fma_f32 v[76:77], v[188:189], v[168:169], v[76:77] op_sel_hi:[0,1,1] neg_lo:[1,0,0] neg_hi:[1,0,0]
    v_pk_fma_f32 v[78:79], v[188:189], v[170:171], v[78:79] op_sel_hi:[0,1,1] neg_lo:[1,0,0] neg_hi:[1,0,0]
    s_nop 0
    v_permlane32_swap_b32 v64, v76
    v_permlane32_swap_b32 v65, v77
    v_permlane32_swap_b32 v66, v78
    v_permlane32_swap_b32 v67, v79
    v_pk_mul_f32 v[64:65], v[204:205], v[64:65] op_sel:[1,0] op_sel_hi:[1,1]
    v_pk_mul_f32 v[66:67], v[204:205], v[66:67] op_sel:[1,0] op_sel_hi:[1,1]
    v_exp_f32 v64, v64
    v_exp_f32 v65, v65
    v_exp_f32 v66, v66
    v_exp_f32 v67, v67
    v_pk_fma_f32 v[64:65], v[64:65], v[206:207], v[206:207] op_sel:[0,1,1] op_sel_hi:[1,1,1]
    v_pk_fma_f32 v[66:67], v[66:67], v[206:207], v[206:207] op_sel:[0,1,1] op_sel_hi:[1,1,1]
    v_rcp_f32 v64, v64
    v_rcp_f32 v65, v65
    v_rcp_f32 v66, v66
    v_rcp_f32 v67, v67
    v_pk_mul_f32 v[76:77], v[76:77], v[64:65]
    v_pk_mul_f32 v[78:79], v[78:79], v[66:67]
    v_cvt_pk_bf16_f32 v202, v76, v77
    v_cvt_pk_bf16_f32 v203, v78, v79
    s_nop 0
    v_permlane16_swap_b32 v200, v202
    v_permlane16_swap_b32 v201, v203
    s_mov_b32 s61, 0
    s_cmp_eq_u32 s58, 0
    s_cbranch_scc1 L_hs_10
    buffer_store_dwordx4 v[192:195], v248, s[36:39], s61 offen nt
    buffer_store_dwordx4 v[196:199], v249, s[36:39], s61 offen nt
    buffer_store_dwordx4 v[200:203], v250, s[36:39], s61 offen nt
    s_branch L_hs_11
L_hs_10:
    buffer_store_dwordx4 v[192:195], v248, s[36:39], s61 offen sc1
    buffer_store_dwordx4 v[196:199], v249, s[36:39], s61 offen sc1
    buffer_store_dwordx4 v[200:203], v250, s[36:39], s61 offen sc1
L_hs_11:
    s_waitcnt lgkmcnt(6)
    v_mfma_f32_16x16x32_bf16 v[80:83], a[0:3], v[128:131], 0
    ds_read_b64_tr_b16 v[144:145], v28 offset:4096
    ds_read_b64_tr_b16 a[192:193], v244 offset:32768
    v_mfma_f32_16x16x32_bf16 v[84:87], a[4:7], v[128:131], 0
    ds_read_b64_tr_b16 v[146:147], v28 offset:6144
    ds_read_b64_tr_b16 a[194:195], v244 offset:33280
    v_mfma_f32_16x16x32_bf16 v[88:91], a[8:11], v[128:131], 0
    ds_read_b64_tr_b16 v[148:149], v29 offset:4096
    ds_read_b64_tr_b16 a[196:197], v244 offset:34816
    s_waitcnt lgkmcnt(10)
    v_mfma_f32_16x16x32_bf16 v[92:95], a[0:3], v[132:135], 0
    ds_read_b64_tr_b16 v[150:151], v29 offset:6144
    ds_read_b64_tr_b16 a[198:199], v244 offset:35328
    v_mfma_f32_16x16x32_bf16 v[96:99], a[4:7], v[132:135], 0
    ds_read_b64_tr_b16 v[152:153], v30 offset:4096
    ds_read_b64_tr_b16 a[200:201], v245 offset:32768
    v_mfma_f32_16x16x32_bf16 v[100:103], a[8:11], v[132:135], 0
    ds_read_b64_tr_b16 v[154:155], v30 offset:6144
    ds_read_b64_tr_b16 a[202:203], v245 offset:33280
    s_waitcnt lgkmcnt(14)
    v_mfma_f32_16x16x32_bf16 v[104:107], a[0:3], v[136:139], 0
    ds_read_b64_tr_b16 v[156:157], v31 offset:4096
    ds_read_b64_tr_b16 a[204:205], v245 offset:34816
    v_mfma_f32_16x16x32_bf16 v[108:111], a[4:7], v[136:139], 0
    ds_read_b64_tr_b16 v[158:159], v31 offset:6144
    ds_read_b64_tr_b16 a[206:207], v245 offset:35328
    v_mfma_f32_16x16x32_bf16 v[112:115], a[8:11], v[136:139], 0
    ds_read_b64_tr_b16 a[208:209], v244 offset:36864
    ds_read_b64_tr_b16 a[210:211], v244 offset:37376
    s_waitcnt lgkmcnt(15)
    v_mfma_f32_16x16x32_bf16 v[116:119], a[0:3], v[140:143], 0
    ds_read_b64_tr_b16 a[212:213], v244 offset:38912
    ds_read_b64_tr_b16 a[214:215], v244 offset:39424
    v_mfma_f32_16x16x32_bf16 v[120:123], a[4:7], v[140:143], 0
    ds_read_b64_tr_b16 a[216:217], v245 offset:36864
    ds_read_b64_tr_b16 a[218:219], v245 offset:37376
    v_mfma_f32_16x16x32_bf16 v[124:127], a[8:11], v[140:143], 0
    ds_read_b64_tr_b16 a[220:221], v245 offset:38912
    ds_read_b64_tr_b16 a[222:223], v245 offset:39424
    s_waitcnt lgkmcnt(15)
    v_mfma_f32_16x16x32_bf16 v[80:83], a[12:15], v[144:147], v[80:83]
    ds_read_b64_tr_b16 v[128:129], v28 offset:8192
    v_min_u32 v14, 31, v1
    v_mfma_f32_16x16x32_bf16 v[84:87], a[16:19], v[144:147], v[84:87]
    ds_read_b64_tr_b16 v[130:131], v28 offset:10240
    v_lshl_add_u32 v14, v14, 2, s86
    v_mfma_f32_16x16x32_bf16 v[88:91], a[20:23], v[144:147], v[88:91]
    ds_read_b64_tr_b16 v[132:133], v29 offset:8192
    v_lshl_add_u32 v15, v1, 4, s87
    s_waitcnt lgkmcnt(15)
    v_mfma_f32_16x16x32_bf16 v[92:95], a[12:15], v[148:151], v[92:95]
    ds_read_b64_tr_b16 v[134:135], v29 offset:10240
    v_and_b32 v12, 31, v1
    v_mfma_f32_16x16x32_bf16 v[96:99], a[16:19], v[148:151], v[96:99]
    ds_read_b64_tr_b16 v[136:137], v30 offset:8192
    v_add_u32 v12, s89, v12
    v_mfma_f32_16x16x32_bf16 v[100:103], a[20:23], v[148:151], v[100:103]
    ds_read_b64_tr_b16 v[138:139], v30 offset:10240
    v_lshrrev_b32 v13, 5, v1
    s_waitcnt lgkmcnt(15)
    v_mfma_f32_16x16x32_bf16 v[104:107], a[12:15], v[152:155], v[104:107]
    ds_read_b64_tr_b16 v[140:141], v31 offset:8192
    v_lshl_add_u32 v13, v13, 3, s90
    v_mfma_f32_16x16x32_bf16 v[108:111], a[16:19], v[152:155], v[108:111]
    ds_read_b64_tr_b16 v[142:143], v31 offset:10240
    v_lshlrev_b32 v16, 12, v13
    v_mfma_f32_16x16x32_bf16 v[112:115], a[20:23], v[152:155], v[112:115]
    s_waitcnt lgkmcnt(8)
    v_lshl_add_u32 v16, v12, 1, v16
    v_add_u32 v16, 9437184, v16
    v_mfma_f32_16x16x32_bf16 v[116:119], a[12:15], v[156:159], v[116:119]
    v_lshlrev_b32 v19, 10, v12
    v_lshl_add_u32 v19, v13, 1, v19
    v_mfma_f32_16x16x32_bf16 v[120:123], a[16:19], v[156:159], v[120:123]
    v_add_u32 v23, 2818048, v15
    v_add_u32 v12, 16384, v16
    v_mfma_f32_16x16x32_bf16 v[124:127], a[20:23], v[156:159], v[124:127]
    v_lshl_add_u32 v18, v1, 4, s91
    v_lshl_add_u32 v17, v1, 4, s92
    s_waitcnt lgkmcnt(6)
    v_mfma_f32_16x16x32_bf16 v[80:83], a[24:27], v[128:131], v[80:83]
    ds_read_b64_tr_b16 v[144:145], v28 offset:12288
    v_lshl_add_u32 v21, v1, 4, s93
    v_mfma_f32_16x16x32_bf16 v[84:87], a[28:31], v[128:131], v[84:87]
    ds_read_b64_tr_b16 v[146:147], v28 offset:14336
    v_lshl_add_u32 v22, v1, 4, s94
    v_mfma_f32_16x16x32_bf16 v[88:91], a[32:35], v[128:131], v[88:91]
    ds_read_b64_tr_b16 v[148:149], v29 offset:12288
    s_waitcnt lgkmcnt(7)
    v_mfma_f32_16x16x32_bf16 v[92:95], a[24:27], v[132:135], v[92:95]
    ds_read_b64_tr_b16 v[150:151], v29 offset:14336
    v_mfma_f32_16x16x32_bf16 v[96:99], a[28:31], v[132:135], v[96:99]
    ds_read_b64_tr_b16 v[152:153], v30 offset:12288
    v_mfma_f32_16x16x32_bf16 v[100:103], a[32:35], v[132:135], v[100:103]
    ds_read_b64_tr_b16 v[154:155], v30 offset:14336
    s_waitcnt lgkmcnt(8)
    v_mfma_f32_16x16x32_bf16 v[104:107], a[24:27], v[136:139], v[104:107]
    ds_read_b64_tr_b16 v[156:157], v31 offset:12288
    v_mfma_f32_16x16x32_bf16 v[108:111], a[28:31], v[136:139], v[108:111]
    ds_read_b64_tr_b16 v[158:159], v31 offset:14336
    v_mfma_f32_16x16x32_bf16 v[112:115], a[32:35], v[136:139], v[112:115]
    s_waitcnt lgkmcnt(8)
    v_mfma_f32_16x16x32_bf16 v[116:119], a[24:27], v[140:143], v[116:119]
    v_mfma_f32_16x16x32_bf16 v[120:123], a[28:31], v[140:143], v[120:123]
    v_mfma_f32_16x16x32_bf16 v[124:127], a[32:35], v[140:143], v[124:127]
    s_barrier
    s_waitcnt lgkmcnt(6)
    v_mfma_f32_16x16x32_bf16 v[80:83], a[36:39], v[144:147], v[80:83]
    ds_read_b64_tr_b16 v[128:129], v28 offset:16384
    s_waitcnt vmcnt(0)
    s_barrier
    v_mfma_f32_16x16x32_bf16 v[84:87], a[40:43], v[144:147], v[84:87]
    ds_read_b64_tr_b16 v[130:131], v28 offset:18432
    v_mfma_f32_16x16x32_bf16 v[88:91], a[44:47], v[144:147], v[88:91]
    ds_read_b64_tr_b16 v[132:133], v29 offset:16384
    s_waitcnt lgkmcnt(7)
    v_mfma_f32_16x16x32_bf16 v[92:95], a[36:39], v[148:151], v[92:95]
    ds_read_b64_tr_b16 v[134:135], v29 offset:18432
    v_mfma_f32_16x16x32_bf16 v[96:99], a[40:43], v[148:151], v[96:99]
    ds_read_b64_tr_b16 v[136:137], v30 offset:16384
    v_mfma_f32_16x16x32_bf16 v[100:103], a[44:47], v[148:151], v[100:103]
    ds_read_b64_tr_b16 v[138:139], v30 offset:18432
    s_waitcnt lgkmcnt(8)
    v_mfma_f32_16x16x32_bf16 v[104:107], a[36:39], v[152:155], v[104:107]
    ds_read_b64_tr_b16 v[140:141], v31 offset:16384
    v_mfma_f32_16x16x32_bf16 v[108:111], a[40:43], v[152:155], v[108:111]
    ds_read_b64_tr_b16 v[142:143], v31 offset:18432
    v_mfma_f32_16x16x32_bf16 v[112:115], a[44:47], v[152:155], v[112:115]
    s_add_u32 m0, s47, 131072
    s_mov_b32 s44, 131072
    buffer_load_dwordx4 v240, s[28:31], s44 offen offset:0 lds
    s_cmp_lg_u32 s3, 0
    s_cbranch_scc1 L_f3_12
    s_lshl_b32 s60, s4, 7
    s_lshl_b32 s61, s5, 2
    s_add_u32 s60, s60, s61
    s_add_u32 s60, s60, 24576
    v_mov_b32 v10, s60
    v_mov_b32 v11, s6
    s_mov_b64 exec, 1
    s_cmp_eq_u32 s58, 0
    s_cbranch_scc1 L_f3_13
    buffer_store_dword v11, v10, s[36:39], 0 offen
    s_mov_b64 exec, -1
    s_branch L_f3_12
L_f3_13:
    buffer_store_dword v11, v10, s[36:39], 0 offen sc1
    s_mov_b64 exec, -1
L_f3_12:
    s_waitcnt lgkmcnt(8)
    v_mfma_f32_16x16x32_bf16 v[116:119], a[36:39], v[156:159], v[116:119]
    buffer_load_dwordx4 v241, s[28:31], s44 offen offset:1024 lds
    v_mfma_f32_16x16x32_bf16 v[120:123], a[40:43], v[156:159], v[120:123]
    buffer_load_dwordx4 v242, s[28:31], s44 offen offset:2048 lds
    v_mfma_f32_16x16x32_bf16 v[124:127], a[44:47], v[156:159], v[124:127]
    buffer_load_dwordx4 v243, s[28:31], s44 offen offset:3072 lds
    s_add_u32 m0, s47, 135168
    s_mov_b32 s44, 163840
    s_waitcnt lgkmcnt(6)
    v_mfma_f32_16x16x32_bf16 v[80:83], a[48:51], v[128:131], v[80:83]
    ds_read_b64_tr_b16 v[144:145], v28 offset:20480
    v_mfma_f32_16x16x32_bf16 v[84:87], a[52:55], v[128:131], v[84:87]
    ds_read_b64_tr_b16 v[146:147], v28 offset:22528
    v_mfma_f32_16x16x32_bf16 v[88:91], a[56:59], v[128:131], v[88:91]
    ds_read_b64_tr_b16 v[148:149], v29 offset:20480
    s_waitcnt lgkmcnt(7)
    v_mfma_f32_16x16x32_bf16 v[92:95], a[48:51], v[132:135], v[92:95]
    ds_read_b64_tr_b16 v[150:151], v29 offset:22528
    v_mfma_f32_16x16x32_bf16 v[96:99], a[52:55], v[132:135], v[96:99]
    ds_read_b64_tr_b16 v[152:153], v30 offset:20480
    v_mfma_f32_16x16x32_bf16 v[100:103], a[56:59], v[132:135], v[100:103]
    ds_read_b64_tr_b16 v[154:155], v30 offset:22528
    s_waitcnt lgkmcnt(8)
    v_mfma_f32_16x16x32_bf16 v[104:107], a[48:51], v[136:139], v[104:107]
    ds_read_b64_tr_b16 v[156:157], v31 offset:20480
    v_mfma_f32_16x16x32_bf16 v[108:111], a[52:55], v[136:139], v[108:111]
    ds_read_b64_tr_b16 v[158:159], v31 offset:22528
    v_mfma_f32_16x16x32_bf16 v[112:115], a[56:59], v[136:139], v[112:115]
    buffer_load_dwordx4 v240, s[28:31], s44 offen offset:0 lds
    s_waitcnt lgkmcnt(8)
    v_mfma_f32_16x16x32_bf16 v[116:119], a[48:51], v[140:143], v[116:119]
    buffer_load_dwordx4 v241, s[28:31], s44 offen offset:1024 lds
    v_mfma_f32_16x16x32_bf16 v[120:123], a[52:55], v[140:143], v[120:123]
    buffer_load_dwordx4 v242, s[28:31], s44 offen offset:2048 lds
    v_mfma_f32_16x16x32_bf16 v[124:127], a[56:59], v[140:143], v[124:127]
    s_waitcnt lgkmcnt(6)
    v_mfma_f32_16x16x32_bf16 v[80:83], a[60:63], v[144:147], v[80:83]
    ds_read_b64_tr_b16 v[128:129], v28 offset:24576
    v_mfma_f32_16x16x32_bf16 v[84:87], a[64:67], v[144:147], v[84:87]
    ds_read_b64_tr_b16 v[130:131], v28 offset:26624
    v_mfma_f32_16x16x32_bf16 v[88:91], a[68:71], v[144:147], v[88:91]
    ds_read_b64_tr_b16 v[132:133], v29 offset:24576
    s_waitcnt lgkmcnt(7)
    v_mfma_f32_16x16x32_bf16 v[92:95], a[60:63], v[148:151], v[92:95]
    ds_read_b64_tr_b16 v[134:135], v29 offset:26624
    v_mfma_f32_16x16x32_bf16 v[96:99], a[64:67], v[148:151], v[96:99]
    ds_read_b64_tr_b16 v[136:137], v30 offset:24576
    v_mfma_f32_16x16x32_bf16 v[100:103], a[68:71], v[148:151], v[100:103]
    ds_read_b64_tr_b16 v[138:139], v30 offset:26624
    s_waitcnt lgkmcnt(8)
    v_mfma_f32_16x16x32_bf16 v[104:107], a[60:63], v[152:155], v[104:107]
    ds_read_b64_tr_b16 v[140:141], v31 offset:24576
    v_mfma_f32_16x16x32_bf16 v[108:111], a[64:67], v[152:155], v[108:111]
    ds_read_b64_tr_b16 v[142:143], v31 offset:26624
    v_mfma_f32_16x16x32_bf16 v[112:115], a[68:71], v[152:155], v[112:115]
    buffer_load_dwordx4 v243, s[28:31], s44 offen offset:3072 lds
    s_waitcnt lgkmcnt(8)
    v_mfma_f32_16x16x32_bf16 v[116:119], a[60:63], v[156:159], v[116:119]
    v_mfma_f32_16x16x32_bf16 v[120:123], a[64:67], v[156:159], v[120:123]
    v_mfma_f32_16x16x32_bf16 v[124:127], a[68:71], v[156:159], v[124:127]
    s_waitcnt lgkmcnt(6)
    v_mfma_f32_16x16x32_bf16 v[80:83], a[72:75], v[128:131], v[80:83]
    ds_read_b64_tr_b16 v[144:145], v28 offset:28672
    ds_read_b64_tr_b16 a[224:225], v246 offset:0
    v_mfma_f32_16x16x32_bf16 v[84:87], a[76:79], v[128:131], v[84:87]
    ds_read_b64_tr_b16 v[146:147], v28 offset:30720
    ds_read_b64_tr_b16 a[226:227], v246 offset:512
    v_mfma_f32_16x16x32_bf16 v[88:91], a[80:83], v[128:131], v[88:91]
    ds_read_b64_tr_b16 v[148:149], v29 offset:28672
    ds_read_b64_tr_b16 a[228:229], v246 offset:2048
    s_waitcnt lgkmcnt(10)
    v_mfma_f32_16x16x32_bf16 v[92:95], a[72:75], v[132:135], v[92:95]
    ds_read_b64_tr_b16 v[150:151], v29 offset:30720
    ds_read_b64_tr_b16 a[230:231], v246 offset:2560
    v_mfma_f32_16x16x32_bf16 v[96:99], a[76:79], v[132:135], v[96:99]
    ds_read_b64_tr_b16 v[152:153], v30 offset:28672
    ds_read_b64_tr_b16 a[232:233], v247 offset:0
    v_mfma_f32_16x16x32_bf16 v[100:103], a[80:83], v[132:135], v[100:103]
    ds_read_b64_tr_b16 v[154:155], v30 offset:30720
    ds_read_b64_tr_b16 a[234:235], v247 offset:512
    s_waitcnt lgkmcnt(14)
    v_mfma_f32_16x16x32_bf16 v[104:107], a[72:75], v[136:139], v[104:107]
    ds_read_b64_tr_b16 v[156:157], v31 offset:28672
    ds_read_b64_tr_b16 a[236:237], v247 offset:2048
    v_mfma_f32_16x16x32_bf16 v[108:111], a[76:79], v[136:139], v[108:111]
    ds_read_b64_tr_b16 v[158:159], v31 offset:30720
    ds_read_b64_tr_b16 a[238:239], v247 offset:2560
    v_mfma_f32_16x16x32_bf16 v[112:115], a[80:83], v[136:139], v[112:115]
    ds_read_b64_tr_b16 a[240:241], v246 offset:4096
    ds_read_b64_tr_b16 a[242:243], v246 offset:4608
    s_waitcnt lgkmcnt(15)
    v_mfma_f32_16x16x32_bf16 v[116:119], a[72:75], v[140:143], v[116:119]
    ds_read_b64_tr_b16 a[244:245], v246 offset:6144
    ds_read_b64_tr_b16 a[246:247], v246 offset:6656
    v_mfma_f32_16x16x32_bf16 v[120:123], a[76:79], v[140:143], v[120:123]
    ds_read_b64_tr_b16 a[248:249], v247 offset:4096
    ds_read_b64_tr_b16 a[250:251], v247 offset:4608
    v_mfma_f32_16x16x32_bf16 v[124:127], a[80:83], v[140:143], v[124:127]
    ds_read_b64_tr_b16 a[252:253], v247 offset:6144
    ds_read_b64_tr_b16 a[254:255], v247 offset:6656
    s_barrier
    s_waitcnt lgkmcnt(15)
    v_mfma_f32_16x16x32_bf16 v[80:83], a[84:87], v[144:147], v[80:83]
    ds_read_b64_tr_b16 v[128:129], v28 offset:32768
    ds_read_b64_tr_b16 v[208:209], v246 offset:8192
    v_mfma_f32_16x16x32_bf16 v[84:87], a[88:91], v[144:147], v[84:87]
    ds_read_b64_tr_b16 v[130:131], v28 offset:34816
    ds_read_b64_tr_b16 v[210:211], v246 offset:8704
    v_mfma_f32_16x16x32_bf16 v[88:91], a[92:95], v[144:147], v[88:91]
    ds_read_b64_tr_b16 v[132:133], v29 offset:32768
    ds_read_b64_tr_b16 v[212:213], v246 offset:10240
    s_waitcnt lgkmcnt(15)
    v_mfma_f32_16x16x32_bf16 v[92:95], a[84:87], v[148:151], v[92:95]
    ds_read_b64_tr_b16 v[134:135], v29 offset:34816
    ds_read_b64_tr_b16 v[214:215], v246 offset:10752
    v_mfma_f32_16x16x32_bf16 v[96:99], a[88:91], v[148:151], v[96:99]
    ds_read_b64_tr_b16 v[136:137], v30 offset:32768
    ds_read_b64_tr_b16 v[216:217], v247 offset:8192
    v_mfma_f32_16x16x32_bf16 v[100:103], a[92:95], v[148:151], v[100:103]
    ds_read_b64_tr_b16 v[138:139], v30 offset:34816
    ds_read_b64_tr_b16 v[218:219], v247 offset:8704
    s_waitcnt lgkmcnt(15)
    v_mfma_f32_16x16x32_bf16 v[104:107], a[84:87], v[152:155], v[104:107]
    ds_read_b64_tr_b16 v[140:141], v31 offset:32768
    ds_read_b64_tr_b16 v[220:221], v247 offset:10240
    v_mfma_f32_16x16x32_bf16 v[108:111], a[88:91], v[152:155], v[108:111]
    ds_read_b64_tr_b16 v[142:143], v31 offset:34816
    ds_read_b64_tr_b16 v[222:223], v247 offset:10752
    v_mfma_f32_16x16x32_bf16 v[112:115], a[92:95], v[152:155], v[112:115]
    ds_read_b64_tr_b16 v[224:225], v246 offset:12288
    ds_read_b64_tr_b16 v[226:227], v246 offset:12800
    s_waitcnt lgkmcnt(15)
    v_mfma_f32_16x16x32_bf16 v[116:119], a[84:87], v[156:159], v[116:119]
    ds_read_b64_tr_b16 v[228:229], v246 offset:14336
    ds_read_b64_tr_b16 v[230:231], v246 offset:14848
    v_mfma_f32_16x16x32_bf16 v[120:123], a[88:91], v[156:159], v[120:123]
    ds_read_b64_tr_b16 v[232:233], v247 offset:12288
    ds_read_b64_tr_b16 v[234:235], v247 offset:12800
    v_mfma_f32_16x16x32_bf16 v[124:127], a[92:95], v[156:159], v[124:127]
    ds_read_b64_tr_b16 v[236:237], v247 offset:14336
    ds_read_b64_tr_b16 v[238:239], v247 offset:14848
    s_waitcnt lgkmcnt(15)
    v_mfma_f32_16x16x32_bf16 v[80:83], a[96:99], v[128:131], v[80:83]
    ds_read_b64_tr_b16 v[144:145], v28 offset:36864
    v_mfma_f32_16x16x32_bf16 v[84:87], a[100:103], v[128:131], v[84:87]
    ds_read_b64_tr_b16 v[146:147], v28 offset:38912
    v_mfma_f32_16x16x32_bf16 v[88:91], a[104:107], v[128:131], v[88:91]
    ds_read_b64_tr_b16 v[148:149], v29 offset:36864
    s_waitcnt lgkmcnt(15)
    v_mfma_f32_16x16x32_bf16 v[92:95], a[96:99], v[132:135], v[92:95]
    ds_read_b64_tr_b16 v[150:151], v29 offset:38912
    v_mfma_f32_16x16x32_bf16 v[96:99], a[100:103], v[132:135], v[96:99]
    ds_read_b64_tr_b16 v[152:153], v30 offset:36864
    v_mfma_f32_16x16x32_bf16 v[100:103], a[104:107], v[132:135], v[100:103]
    ds_read_b64_tr_b16 v[154:155], v30 offset:38912
    s_waitcnt lgkmcnt(15)
    v_mfma_f32_16x16x32_bf16 v[104:107], a[96:99], v[136:139], v[104:107]
    ds_read_b64_tr_b16 v[156:157], v31 offset:36864
    v_mfma_f32_16x16x32_bf16 v[108:111], a[100:103], v[136:139], v[108:111]
    ds_read_b64_tr_b16 v[158:159], v31 offset:38912
    v_mfma_f32_16x16x32_bf16 v[112:115], a[104:107], v[136:139], v[112:115]
    s_waitcnt lgkmcnt(8)
    v_mfma_f32_16x16x32_bf16 v[116:119], a[96:99], v[140:143], v[116:119]
    s_add_u32 m0, s57, 0
    s_mov_b32 s44, 196608
    buffer_load_dwordx4 v240, s[28:31], s44 offen offset:0 lds
    v_mfma_f32_16x16x32_bf16 v[120:123], a[100:103], v[140:143], v[120:123]
    buffer_load_dwordx4 v241, s[28:31], s44 offen offset:1024 lds
    v_mfma_f32_16x16x32_bf16 v[124:127], a[104:107], v[140:143], v[124:127]
    buffer_load_dwordx4 v242, s[28:31], s44 offen offset:2048 lds
    s_waitcnt lgkmcnt(6)
    v_mfma_f32_16x16x32_bf16 v[80:83], a[108:111], v[144:147], v[80:83]
    ds_read_b64_tr_b16 v[128:129], v28 offset:40960
    v_mfma_f32_16x16x32_bf16 v[84:87], a[112:115], v[144:147], v[84:87]
    ds_read_b64_tr_b16 v[130:131], v28 offset:43008
    v_mfma_f32_16x16x32_bf16 v[88:91], a[116:119], v[144:147], v[88:91]
    ds_read_b64_tr_b16 v[132:133], v29 offset:40960
    s_waitcnt lgkmcnt(7)
    v_mfma_f32_16x16x32_bf16 v[92:95], a[108:111], v[148:151], v[92:95]
    ds_read_b64_tr_b16 v[134:135], v29 offset:43008
    v_mfma_f32_16x16x32_bf16 v[96:99], a[112:115], v[148:151], v[96:99]
    ds_read_b64_tr_b16 v[136:137], v30 offset:40960
    v_mfma_f32_16x16x32_bf16 v[100:103], a[116:119], v[148:151], v[100:103]
    ds_read_b64_tr_b16 v[138:139], v30 offset:43008
    s_waitcnt lgkmcnt(8)
    v_mfma_f32_16x16x32_bf16 v[104:107], a[108:111], v[152:155], v[104:107]
    ds_read_b64_tr_b16 v[140:141], v31 offset:40960
    v_mfma_f32_16x16x32_bf16 v[108:111], a[112:115], v[152:155], v[108:111]
    ds_read_b64_tr_b16 v[142:143], v31 offset:43008
    v_mfma_f32_16x16x32_bf16 v[112:115], a[116:119], v[152:155], v[112:115]
    buffer_load_dwordx4 v243, s[28:31], s44 offen offset:3072 lds
    s_add_u32 m0, s57, 4096
    s_mov_b32 s44, 229376
    s_waitcnt lgkmcnt(8)
    v_mfma_f32_16x16x32_bf16 v[116:119], a[108:111], v[156:159], v[116:119]
    buffer_load_dwordx4 v240, s[28:31], s44 offen offset:0 lds
    v_mfma_f32_16x16x32_bf16 v[120:123], a[112:115], v[156:159], v[120:123]
    buffer_load_dwordx4 v241, s[28:31], s44 offen offset:1024 lds
    v_mfma_f32_16x16x32_bf16 v[124:127], a[116:119], v[156:159], v[124:127]
    buffer_load_dwordx4 v242, s[28:31], s44 offen offset:2048 lds
    s_waitcnt lgkmcnt(6)
    v_mfma_f32_16x16x32_bf16 v[80:83], a[120:123], v[128:131], v[80:83]
    ds_read_b64_tr_b16 v[144:145], v28 offset:45056
    v_mfma_f32_16x16x32_bf16 v[84:87], a[124:127], v[128:131], v[84:87]
    ds_read_b64_tr_b16 v[146:147], v28 offset:47104
    v_mfma_f32_16x16x32_bf16 v[88:91], a[128:131], v[128:131], v[88:91]
    ds_read_b64_tr_b16 v[148:149], v29 offset:45056
    buffer_load_dword v253, v14, s[36:39], 0 offen offset:0 sc1
    s_waitcnt lgkmcnt(7)
    v_mfma_f32_16x16x32_bf16 v[92:95], a[120:123], v[132:135], v[92:95]
    ds_read_b64_tr_b16 v[150:151], v29 offset:47104
    v_mfma_f32_16x16x32_bf16 v[96:99], a[124:127], v[132:135], v[96:99]
    ds_read_b64_tr_b16 v[152:153], v30 offset:45056
    v_mfma_f32_16x16x32_bf16 v[100:103], a[128:131], v[132:135], v[100:103]
    ds_read_b64_tr_b16 v[154:155], v30 offset:47104
    s_waitcnt lgkmcnt(8)
    v_mfma_f32_16x16x32_bf16 v[104:107], a[120:123], v[136:139], v[104:107]
    ds_read_b64_tr_b16 v[156:157], v31 offset:45056
    v_mfma_f32_16x16x32_bf16 v[108:111], a[124:127], v[136:139], v[108:111]
    ds_read_b64_tr_b16 v[158:159], v31 offset:47104
    v_mfma_f32_16x16x32_bf16 v[112:115], a[128:131], v[136:139], v[112:115]
    buffer_load_dwordx4 v243, s[28:31], s44 offen offset:3072 lds
    s_add_u32 m0, s57, 8192
    s_mov_b32 s44, 262144
    s_waitcnt lgkmcnt(8)
    v_mfma_f32_16x16x32_bf16 v[116:119], a[120:123], v[140:143], v[116:119]
    buffer_load_dwordx4 v240, s[28:31], s44 offen offset:0 lds
    v_mfma_f32_16x16x32_bf16 v[120:123], a[124:127], v[140:143], v[120:123]
    s_movk_i32 s51, 16384
    buffer_load_dwordx4 v[176:179], v251, s[36:39], s51 offen offset:0 sc1
    buffer_load_dwordx4 v[180:183], v251, s[36:39], s51 offen offset:256 sc1
    buffer_load_dwordx4 v[184:187], v251, s[36:39], s51 offen offset:512 sc1
    buffer_load_dwordx4 v[188:191], v251, s[36:39], s51 offen offset:768 sc1
    v_mfma_f32_16x16x32_bf16 v[124:127], a[128:131], v[140:143], v[124:127]
    buffer_load_dwordx4 v241, s[28:31], s44 offen offset:1024 lds
    s_barrier
    s_waitcnt lgkmcnt(6)
    v_mfma_f32_16x16x32_bf16 v[80:83], a[132:135], v[144:147], v[80:83]
    ds_read_b64_tr_b16 v[128:129], v28 offset:49152
    v_mfma_f32_16x16x32_bf16 v[84:87], a[136:139], v[144:147], v[84:87]
    ds_read_b64_tr_b16 v[130:131], v28 offset:51200
    v_mfma_f32_16x16x32_bf16 v[88:91], a[140:143], v[144:147], v[88:91]
    ds_read_b64_tr_b16 v[132:133], v29 offset:49152
    s_waitcnt lgkmcnt(7)
    v_mfma_f32_16x16x32_bf16 v[92:95], a[132:135], v[148:151], v[92:95]
    ds_read_b64_tr_b16 v[134:135], v29 offset:51200
    v_mfma_f32_16x16x32_bf16 v[96:99], a[136:139], v[148:151], v[96:99]
    ds_read_b64_tr_b16 v[136:137], v30 offset:49152
    v_mfma_f32_16x16x32_bf16 v[100:103], a[140:143], v[148:151], v[100:103]
    ds_read_b64_tr_b16 v[138:139], v30 offset:51200
    s_waitcnt lgkmcnt(8)
    v_mfma_f32_16x16x32_bf16 v[104:107], a[132:135], v[152:155], v[104:107]
    ds_read_b64_tr_b16 v[140:141], v31 offset:49152
    v_mfma_f32_16x16x32_bf16 v[108:111], a[136:139], v[152:155], v[108:111]
    ds_read_b64_tr_b16 v[142:143], v31 offset:51200
    v_mfma_f32_16x16x32_bf16 v[112:115], a[140:143], v[152:155], v[112:115]
    buffer_load_dwordx4 v242, s[28:31], s44 offen offset:2048 lds
    s_waitcnt lgkmcnt(8)
    v_mfma_f32_16x16x32_bf16 v[116:119], a[132:135], v[156:159], v[116:119]
    buffer_load_dwordx4 v243, s[28:31], s44 offen offset:3072 lds
    v_mfma_f32_16x16x32_bf16 v[120:123], a[136:139], v[156:159], v[120:123]
    v_mfma_f32_16x16x32_bf16 v[124:127], a[140:143], v[156:159], v[124:127]
    s_waitcnt lgkmcnt(6)
    v_mfma_f32_16x16x32_bf16 v[80:83], a[144:147], v[128:131], v[80:83]
    ds_read_b64_tr_b16 v[144:145], v28 offset:53248
    s_waitcnt vmcnt(9)
    v_cmp_ne_u32 vcc, s6, v253
    s_and_b32 vcc_lo, vcc_lo, s101
    s_mov_b32 vcc_hi, 0
    s_or_b64 vcc, vcc, vcc
    s_cbranch_vccnz L_f3_0_retry
L_f3_0_ok:
    v_mfma_f32_16x16x32_bf16 v[84:87], a[148:151], v[128:131], v[84:87]
    ds_read_b64_tr_b16 v[146:147], v28 offset:55296
    buffer_load_dwordx4 a[0:3], v15, s[36:39], 0 offen offset:0 sc1
    v_mfma_f32_16x16x32_bf16 v[88:91], a[152:155], v[128:131], v[88:91]
    ds_read_b64_tr_b16 v[148:149], v29 offset:53248
    s_waitcnt lgkmcnt(7)
    v_mfma_f32_16x16x32_bf16 v[92:95], a[144:147], v[132:135], v[92:95]
    ds_read_b64_tr_b16 v[150:151], v29 offset:55296
    buffer_load_dwordx4 a[4:7], v15, s[36:39], 0 offen offset:1024 sc1
    v_mfma_f32_16x16x32_bf16 v[96:99], a[148:151], v[132:135], v[96:99]
    ds_read_b64_tr_b16 v[152:153], v30 offset:53248
    v_mfma_f32_16x16x32_bf16 v[100:103], a[152:155], v[132:135], v[100:103]
    ds_read_b64_tr_b16 v[154:155], v30 offset:55296
    s_waitcnt lgkmcnt(8)
    v_mfma_f32_16x16x32_bf16 v[104:107], a[144:147], v[136:139], v[104:107]
    ds_read_b64_tr_b16 v[156:157], v31 offset:53248
    v_mfma_f32_16x16x32_bf16 v[108:111], a[148:151], v[136:139], v[108:111]
    ds_read_b64_tr_b16 v[158:159], v31 offset:55296
    buffer_load_dwordx4 a[8:11], v15, s[36:39], 0 offen offset:2048 sc1
    v_mfma_f32_16x16x32_bf16 v[112:115], a[152:155], v[136:139], v[112:115]
    s_waitcnt lgkmcnt(8)
    v_mfma_f32_16x16x32_bf16 v[116:119], a[144:147], v[140:143], v[116:119]
    v_mfma_f32_16x16x32_bf16 v[120:123], a[148:151], v[140:143], v[120:123]
    buffer_load_dwordx4 a[12:15], v15, s[36:39], 0 offen offset:3072 sc1
    v_mfma_f32_16x16x32_bf16 v[124:127], a[152:155], v[140:143], v[124:127]
    s_waitcnt lgkmcnt(6)
    v_mfma_f32_16x16x32_bf16 v[80:83], a[156:159], v[144:147], v[80:83]
    ds_read_b64_tr_b16 v[128:129], v28 offset:57344
    v_mfma_f32_16x16x32_bf16 v[84:87], a[160:163], v[144:147], v[84:87]
    ds_read_b64_tr_b16 v[130:131], v28 offset:59392
    v_mfma_f32_16x16x32_bf16 v[88:91], a[164:167], v[144:147], v[88:91]
    ds_read_b64_tr_b16 v[132:133], v29 offset:57344
    buffer_load_dwordx4 a[16:19], v15, s[36:39], s52 offen offset:0 sc1
    s_waitcnt lgkmcnt(7)
    v_mfma_f32_16x16x32_bf16 v[92:95], a[156:159], v[148:151], v[92:95]
    ds_read_b64_tr_b16 v[134:135], v29 offset:59392
    v_mfma_f32_16x16x32_bf16 v[96:99], a[160:163], v[148:151], v[96:99]
    ds_read_b64_tr_b16 v[136:137], v30 offset:57344
    v_mfma_f32_16x16x32_bf16 v[100:103], a[164:167], v[148:151], v[100:103]
    ds_read_b64_tr_b16 v[138:139], v30 offset:59392
    buffer_load_dwordx4 a[20:23], v15, s[36:39], s52 offen offset:1024 sc1
    s_waitcnt lgkmcnt(8)
    v_mfma_f32_16x16x32_bf16 v[104:107], a[156:159], v[152:155], v[104:107]
    ds_read_b64_tr_b16 v[140:141], v31 offset:57344
    v_mfma_f32_16x16x32_bf16 v[108:111], a[160:163], v[152:155], v[108:111]
    ds_read_b64_tr_b16 v[142:143], v31 offset:59392
    v_mfma_f32_16x16x32_bf16 v[112:115], a[164:167], v[152:155], v[112:115]
    s_waitcnt lgkmcnt(8)
    v_mfma_f32_16x16x32_bf16 v[116:119], a[156:159], v[156:159], v[116:119]
    buffer_load_dwordx4 a[24:27], v15, s[36:39], s52 offen offset:2048 sc1
    v_mfma_f32_16x16x32_bf16 v[120:123], a[160:163], v[156:159], v[120:123]
    v_mfma_f32_16x16x32_bf16 v[124:127], a[164:167], v[156:159], v[124:127]
    s_waitcnt lgkmcnt(6)
    v_mfma_f32_16x16x32_bf16 v[80:83], a[168:171], v[128:131], v[80:83]
    ds_read_b64_tr_b16 v[144:145], v28 offset:61440
    buffer_load_dwordx4 a[28:31], v15, s[36:39], s52 offen offset:3072 sc1
    v_mfma_f32_16x16x32_bf16 v[84:87], a[172:175], v[128:131], v[84:87]
    ds_read_b64_tr_b16 v[146:147], v28 offset:63488
    v_mfma_f32_16x16x32_bf16 v[88:91], a[176:179], v[128:131], v[88:91]
    ds_read_b64_tr_b16 v[148:149], v29 offset:61440
    s_waitcnt lgkmcnt(7)
    v_mfma_f32_16x16x32_bf16 v[92:95], a[168:171], v[132:135], v[92:95]
    ds_read_b64_tr_b16 v[150:151], v29 offset:63488
    v_mfma_f32_16x16x32_bf16 v[96:99], a[172:175], v[132:135], v[96:99]
    ds_read_b64_tr_b16 v[152:153], v30 offset:61440
    buffer_load_dwordx4 a[32:35], v15, s[36:39], s88 offen offset:2048 sc1
    v_mfma_f32_16x16x32_bf16 v[100:103], a[176:179], v[132:135], v[100:103]
    ds_read_b64_tr_b16 v[154:155], v30 offset:63488
    s_waitcnt lgkmcnt(8)
    v_mfma_f32_16x16x32_bf16 v[104:107], a[168:171], v[136:139], v[104:107]
    ds_read_b64_tr_b16 v[156:157], v31 offset:61440
    v_mfma_f32_16x16x32_bf16 v[108:111], a[172:175], v[136:139], v[108:111]
    ds_read_b64_tr_b16 v[158:159], v31 offset:63488
    buffer_load_dwordx4 a[36:39], v15, s[36:39], s88 offen offset:3072 sc1
    v_mfma_f32_16x16x32_bf16 v[112:115], a[176:179], v[136:139], v[112:115]
    s_waitcnt lgkmcnt(8)
    v_mfma_f32_16x16x32_bf16 v[116:119], a[168:171], v[140:143], v[116:119]
    v_mfma_f32_16x16x32_bf16 v[120:123], a[172:175], v[140:143], v[120:123]
    v_mfma_f32_16x16x32_bf16 v[124:127], a[176:179], v[140:143], v[124:127]
    s_cmp_eq_u32 s3, 3
    s_cbranch_scc1 L_s3_14
    buffer_load_dwordx4 a[40:43], v15, s[36:39], s95 offen offset:0 sc1
    buffer_load_dwordx4 a[44:47], v15, s[36:39], s95 offen offset:1024 sc1
L_s3_14:
    s_waitcnt lgkmcnt(6)
    v_mfma_f32_16x16x32_bf16 v[80:83], a[180:183], v[144:147], v[80:83]
    v_mfma_f32_16x16x32_bf16 v[84:87], a[184:187], v[144:147], v[84:87]
    v_mfma_f32_16x16x32_bf16 v[88:91], a[188:191], v[144:147], v[88:91]
    buffer_load_dwordx4 a[48:51], v15, s[36:39], s54 offen offset:0 sc1
    s_waitcnt lgkmcnt(4)
    v_mfma_f32_16x16x32_bf16 v[92:95], a[180:183], v[148:151], v[92:95]
    v_mfma_f32_16x16x32_bf16 v[96:99], a[184:187], v[148:151], v[96:99]
    v_mfma_f32_16x16x32_bf16 v[100:103], a[188:191], v[148:151], v[100:103]
    s_waitcnt lgkmcnt(2)
    v_mfma_f32_16x16x32_bf16 v[104:107], a[180:183], v[152:155], v[104:107]
    buffer_load_dwordx4 a[52:55], v15, s[36:39], s54 offen offset:1024 sc1
    v_mfma_f32_16x16x32_bf16 v[108:111], a[184:187], v[152:155], v[108:111]
    v_mfma_f32_16x16x32_bf16 v[112:115], a[188:191], v[152:155], v[112:115]
    s_waitcnt lgkmcnt(0)
    v_mfma_f32_16x16x32_bf16 v[116:119], a[180:183], v[156:159], v[116:119]
    buffer_load_dwordx4 a[56:59], v15, s[36:39], s54 offen offset:2048 sc1
    v_mfma_f32_16x16x32_bf16 v[120:123], a[184:187], v[156:159], v[120:123]
    v_mfma_f32_16x16x32_bf16 v[124:127], a[188:191], v[156:159], v[124:127]
    buffer_load_dwordx4 a[60:63], v15, s[36:39], s54 offen offset:3072 sc1
    buffer_load_dwordx4 a[64:67], v15, s[36:39], s53 offen offset:0 sc1
    buffer_load_dwordx4 a[68:71], v15, s[36:39], s53 offen offset:1024 sc1
    buffer_load_dwordx4 a[72:75], v15, s[36:39], s53 offen offset:2048 sc1
    buffer_load_dwordx4 a[76:79], v15, s[36:39], s53 offen offset:3072 sc1
    buffer_load_dwordx4 a[80:83], v15, s[36:39], s88 offen offset:0 sc1
    buffer_load_dwordx4 a[84:87], v15, s[36:39], s88 offen offset:1024 sc1
    s_waitcnt vmcnt(25)
    v_bitop3_b32 v172, v178, v182, s6 bitop3:0x7e
    v_bitop3_b32 v173, v179, v183, s7 bitop3:0x7e
    s_waitcnt vmcnt(23)
    v_bitop3_b32 v174, v186, v190, s6 bitop3:0x7e
    v_bitop3_b32 v175, v187, v191, s7 bitop3:0x7e
    v_or3_b32 v254, v172, v173, v174
    v_or_b32 v254, v254, v175
    v_cmp_ne_u32 vcc, 0, v254
    s_cbranch_vccnz L_st2_1_retry
L_st2_1_ok:
    v_cmp_gt_u32 vcc, 32, v1
    s_nop 1
    v_cndmask_b32 v206, v181, v177, vcc
    v_cndmask_b32 v207, v189, v185, vcc
    v_rcp_f32 v204, v206
    v_rcp_f32 v205, v207
    v_mul_f32 v204, 0xbfb8aa3b, v204
    v_mul_f32 v205, 0xbfb8aa3b, v205
    v_pk_fma_f32 v[80:81], v[176:177], v[160:161], v[80:81] op_sel_hi:[0,1,1] neg_lo:[1,0,0] neg_hi:[1,0,0]
    v_pk_fma_f32 v[82:83], v[176:177], v[162:163], v[82:83] op_sel_hi:[0,1,1] neg_lo:[1,0,0] neg_hi:[1,0,0]
    v_pk_fma_f32 v[92:93], v[180:181], v[160:161], v[92:93] op_sel_hi:[0,1,1] neg_lo:[1,0,0] neg_hi:[1,0,0]
    v_pk_fma_f32 v[94:95], v[180:181], v[162:163], v[94:95] op_sel_hi:[0,1,1] neg_lo:[1,0,0] neg_hi:[1,0,0]
    s_nop 0
    v_permlane32_swap_b32 v80, v92
    v_permlane32_swap_b32 v81, v93
    v_permlane32_swap_b32 v82, v94
    v_permlane32_swap_b32 v83, v95
    v_pk_mul_f32 v[80:81], v[204:205], v[80:81] op_sel:[0,0] op_sel_hi:[0,1]
    v_pk_mul_f32 v[82:83], v[204:205], v[82:83] op_sel:[0,0] op_sel_hi:[0,1]
    v_exp_f32 v80, v80
    v_exp_f32 v81, v81
    v_exp_f32 v82, v82
    v_exp_f32 v83, v83
    v_pk_fma_f32 v[80:81], v[80:81], v[206:207], v[206:207] op_sel:[0,0,0] op_sel_hi:[1,0,0]
    v_pk_fma_f32 v[82:83], v[82:83], v[206:207], v[206:207] op_sel:[0,0,0] op_sel_hi:[1,0,0]
    v_rcp_f32 v80, v80
    v_rcp_f32 v81, v81
    v_rcp_f32 v82, v82
    v_rcp_f32 v83, v83
    v_pk_mul_f32 v[92:93], v[92:93], v[80:81]
    v_pk_mul_f32 v[94:95], v[94:95], v[82:83]
    v_cvt_pk_bf16_f32 v192, v92, v93
    v_cvt_pk_bf16_f32 v193, v94, v95
    v_pk_fma_f32 v[84:85], v[176:177], v[164:165], v[84:85] op_sel_hi:[0,1,1] neg_lo:[1,0,0] neg_hi:[1,0,0]
    v_pk_fma_f32 v[86:87], v[176:177], v[166:167], v[86:87] op_sel_hi:[0,1,1] neg_lo:[1,0,0] neg_hi:[1,0,0]
    v_pk_fma_f32 v[96:97], v[180:181], v[164:165], v[96:97] op_sel_hi:[0,1,1] neg_lo:[1,0,0] neg_hi:[1,0,0]
    v_pk_fma_f32 v[98:99], v[180:181], v[166:167], v[98:99] op_sel_hi:[0,1,1] neg_lo:[1,0,0] neg_hi:[1,0,0]
    s_nop 0
    v_permlane32_swap_b32 v84, v96
    v_permlane32_swap_b32 v85, v97
    v_permlane32_swap_b32 v86, v98
    v_permlane32_swap_b32 v87, v99
    v_pk_mul_f32 v[84:85], v[204:205], v[84:85] op_sel:[0,0] op_sel_hi:[0,1]
    v_pk_mul_f32 v[86:87], v[204:205], v[86:87] op_sel:[0,0] op_sel_hi:[0,1]
    v_exp_f32 v84, v84
    v_exp_f32 v85, v85
    v_exp_f32 v86, v86
    v_exp_f32 v87, v87
    v_pk_fma_f32 v[84:85], v[84:85], v[206:207], v[206:207] op_sel:[0,0,0] op_sel_hi:[1,0,0]
    v_pk_fma_f32 v[86:87], v[86:87], v[206:207], v[206:207] op_sel:[0,0,0] op_sel_hi:[1,0,0]
    v_rcp_f32 v84, v84
    v_rcp_f32 v85, v85
    v_rcp_f32 v86, v86
    v_rcp_f32 v87, v87
    v_pk_mul_f32 v[96:97], v[96:97], v[84:85]
    v_pk_mul_f32 v[98:99], v[98:99], v[86:87]
    v_cvt_pk_bf16_f32 v194, v96, v97
    v_cvt_pk_bf16_f32 v195, v98, v99
    v_pk_fma_f32 v[88:89], v[176:177], v[168:169], v[88:89] op_sel_hi:[0,1,1] neg_lo:[1,0,0] neg_hi:[1,0,0]
    v_pk_fma_f32 v[90:91], v[176:177], v[170:171], v[90:91] op_sel_hi:[0,1,1] neg_lo:[1,0,0] neg_hi:[1,0,0]
    v_pk_fma_f32 v[100:101], v[180:181], v[168:169], v[100:101] op_sel_hi:[0,1,1] neg_lo:[1,0,0] neg_hi:[1,0,0]
    v_pk_fma_f32 v[102:103], v[180:181], v[170:171], v[102:103] op_sel_hi:[0,1,1] neg_lo:[1,0,0] neg_hi:[1,0,0]
    s_nop 0
    v_permlane32_swap_b32 v88, v100
    v_permlane32_swap_b32 v89, v101
    v_permlane32_swap_b32 v90, v102
    v_permlane32_swap_b32 v91, v103
    v_pk_mul_f32 v[88:89], v[204:205], v[88:89] op_sel:[0,0] op_sel_hi:[0,1]
    v_pk_mul_f32 v[90:91], v[204:205], v[90:91] op_sel:[0,0] op_sel_hi:[0,1]
    v_exp_f32 v88, v88
    v_exp_f32 v89, v89
    v_exp_f32 v90, v90
    v_exp_f32 v91, v91
    v_pk_fma_f32 v[88:89], v[88:89], v[206:207], v[206:207] op_sel:[0,0,0] op_sel_hi:[1,0,0]
    v_pk_fma_f32 v[90:91], v[90:91], v[206:207], v[206:207] op_sel:[0,0,0] op_sel_hi:[1,0,0]
    v_rcp_f32 v88, v88
    v_rcp_f32 v89, v89
    v_rcp_f32 v90, v90
    v_rcp_f32 v91, v91
    v_pk_mul_f32 v[100:101], v[100:101], v[88:89]
    v_pk_mul_f32 v[102:103], v[102:103], v[90:91]
    v_cvt_pk_bf16_f32 v200, v100, v101
    v_cvt_pk_bf16_f32 v201, v102, v103
    v_pk_fma_f32 v[104:105], v[184:185], v[160:161], v[104:105] op_sel_hi:[0,1,1] neg_lo:[1,0,0] neg_hi:[1,0,0]
    v_pk_fma_f32 v[106:107], v[184:185], v[162:163], v[106:107] op_sel_hi:[0,1,1] neg_lo:[1,0,0] neg_hi:[1,0,0]
    v_pk_fma_f32 v[116:117], v[188:189], v[160:161], v[116:117] op_sel_hi:[0,1,1] neg_lo:[1,0,0] neg_hi:[1,0,0]
    v_pk_fma_f32 v[118:119], v[188:189], v[162:163], v[118:119] op_sel_hi:[0,1,1] neg_lo:[1,0,0] neg_hi:[1,0,0]
    s_nop 0
    v_permlane32_swap_b32 v104, v116
    v_permlane32_swap_b32 v105, v117
    v_permlane32_swap_b32 v106, v118
    v_permlane32_swap_b32 v107, v119
    v_pk_mul_f32 v[104:105], v[204:205], v[104:105] op_sel:[1,0] op_sel_hi:[1,1]
    v_pk_mul_f32 v[106:107], v[204:205], v[106:107] op_sel:[1,0] op_sel_hi:[1,1]
    v_exp_f32 v104, v104
    v_exp_f32 v105, v105
    v_exp_f32 v106, v106
    v_exp_f32 v107, v107
    v_pk_fma_f32 v[104:105], v[104:105], v[206:207], v[206:207] op_sel:[0,1,1] op_sel_hi:[1,1,1]
    v_pk_fma_f32 v[106:107], v[106:107], v[206:207], v[206:207] op_sel:[0,1,1] op_sel_hi:[1,1,1]
    v_rcp_f32 v104, v104
    v_rcp_f32 v105, v105
    v_rcp_f32 v106, v106
    v_rcp_f32 v107, v107
    v_pk_mul_f32 v[116:117], v[116:117], v[104:105]
    v_pk_mul_f32 v[118:119], v[118:119], v[106:107]
    v_cvt_pk_bf16_f32 v196, v116, v117
    v_cvt_pk_bf16_f32 v197, v118, v119
    v_pk_fma_f32 v[108:109], v[184:185], v[164:165], v[108:109] op_sel_hi:[0,1,1] neg_lo:[1,0,0] neg_hi:[1,0,0]
    v_pk_fma_f32 v[110:111], v[184:185], v[166:167], v[110:111] op_sel_hi:[0,1,1] neg_lo:[1,0,0] neg_hi:[1,0,0]
    v_pk_fma_f32 v[120:121], v[188:189], v[164:165], v[120:121] op_sel_hi:[0,1,1] neg_lo:[1,0,0] neg_hi:[1,0,0]
    v_pk_fma_f32 v[122:123], v[188:189], v[166:167], v[122:123] op_sel_hi:[0,1,1] neg_lo:[1,0,0] neg_hi:[1,0,0]
    s_nop 0
    v_permlane32_swap_b32 v108, v120
    v_permlane32_swap_b32 v109, v121
    v_permlane32_swap_b32 v110, v122
    v_permlane32_swap_b32 v111, v123
    v_pk_mul_f32 v[108:109], v[204:205], v[108:109] op_sel:[1,0] op_sel_hi:[1,1]
    v_pk_mul_f32 v[110:111], v[204:205], v[110:111] op_sel:[1,0] op_sel_hi:[1,1]
    v_exp_f32 v108, v108
    v_exp_f32 v109, v109
    v_exp_f32 v110, v110
    v_exp_f32 v111, v111
    v_pk_fma_f32 v[108:109], v[108:109], v[206:207], v[206:207] op_sel:[0,1,1] op_sel_hi:[1,1,1]
    v_pk_fma_f32 v[110:111], v[110:111], v[206:207], v[206:207] op_sel:[0,1,1] op_sel_hi:[1,1,1]
    v_rcp_f32 v108, v108
    v_rcp_f32 v109, v109
    v_rcp_f32 v110, v110
    v_rcp_f32 v111, v111
    v_pk_mul_f32 v[120:121], v[120:121], v[108:109]
    v_pk_mul_f32 v[122:123], v[122:123], v[110:111]
    v_cvt_pk_bf16_f32 v198, v120, v121
    v_cvt_pk_bf16_f32 v199, v122, v123
    v_pk_fma_f32 v[112:113], v[184:185], v[168:169], v[112:113] op_sel_hi:[0,1,1] neg_lo:[1,0,0] neg_hi:[1,0,0]
    v_pk_fma_f32 v[114:115], v[184:185], v[170:171], v[114:115] op_sel_hi:[0,1,1] neg_lo:[1,0,0] neg_hi:[1,0,0]
    v_pk_fma_f32 v[124:125], v[188:189], v[168:169], v[124:125] op_sel_hi:[0,1,1] neg_lo:[1,0,0] neg_hi:[1,0,0]
    v_pk_fma_f32 v[126:127], v[188:189], v[170:171], v[126:127] op_sel_hi:[0,1,1] neg_lo:[1,0,0] neg_hi:[1,0,0]
    s_nop 0
    v_permlane32_swap_b32 v112, v124
    v_permlane32_swap_b32 v113, v125
    v_permlane32_swap_b32 v114, v126
    v_permlane32_swap_b32 v115, v127
    v_pk_mul_f32 v[112:113], v[204:205], v[112:113] op_sel:[1,0] op_sel_hi:[1,1]
    v_pk_mul_f32 v[114:115], v[204:205], v[114:115] op_sel:[1,0] op_sel_hi:[1,1]
    v_exp_f32 v112, v112
    v_exp_f32 v113, v113
    v_exp_f32 v114, v114
    v_exp_f32 v115, v115
    v_pk_fma_f32 v[112:113], v[112:113], v[206:207], v[206:207] op_sel:[0,1,1] op_sel_hi:[1,1,1]
    v_pk_fma_f32 v[114:115], v[114:115], v[206:207], v[206:207] op_sel:[0,1,1] op_sel_hi:[1,1,1]
    v_rcp_f32 v112, v112
    v_rcp_f32 v113, v113
    v_rcp_f32 v114, v114
    v_rcp_f32 v115, v115
    v_pk_mul_f32 v[124:125], v[124:125], v[112:113]
    v_pk_mul_f32 v[126:127], v[126:127], v[114:115]
    v_cvt_pk_bf16_f32 v202, v124, v125
    v_cvt_pk_bf16_f32 v203, v126, v127
    s_nop 0
    v_permlane16_swap_b32 v200, v202
    v_permlane16_swap_b32 v201, v203
    s_mov_b32 s61, 2818048
    s_cmp_eq_u32 s58, 0
    s_cbranch_scc1 L_hs_15
    buffer_store_dwordx4 v[192:195], v248, s[36:39], s61 offen nt
    buffer_store_dwordx4 v[196:199], v249, s[36:39], s61 offen nt
    buffer_store_dwordx4 v[200:203], v250, s[36:39], s61 offen nt
    s_branch L_hs_16
L_hs_15:
    buffer_store_dwordx4 v[192:195], v248, s[36:39], s61 offen sc1
    buffer_store_dwordx4 v[196:199], v249, s[36:39], s61 offen sc1
    buffer_store_dwordx4 v[200:203], v250, s[36:39], s61 offen sc1
L_hs_16:
    ds_read_b64_tr_b16 a[88:89], v244 offset:32768
    ds_read_b64_tr_b16 a[90:91], v244 offset:33280
    ds_read_b64_tr_b16 a[92:93], v244 offset:34816
    ds_read_b64_tr_b16 a[94:95], v244 offset:35328
    ds_read_b64_tr_b16 a[96:97], v245 offset:32768
    ds_read_b64_tr_b16 a[98:99], v245 offset:33280
    ds_read_b64_tr_b16 a[100:101], v245 offset:34816
    ds_read_b64_tr_b16 a[102:103], v245 offset:35328
    ds_read_b64_tr_b16 a[104:105], v244 offset:36864
    ds_read_b64_tr_b16 a[106:107], v244 offset:37376
    ds_read_b64_tr_b16 a[108:109], v244 offset:38912
    ds_read_b64_tr_b16 a[110:111], v244 offset:39424
    ds_read_b64_tr_b16 a[112:113], v245 offset:36864
    ds_read_b64_tr_b16 a[114:115], v245 offset:37376
    ds_read_b64_tr_b16 a[116:117], v245 offset:38912
    ds_read_b64_tr_b16 a[118:119], v245 offset:39424
    ds_read_b64_tr_b16 a[120:121], v246 offset:0
    ds_read_b64_tr_b16 a[122:123], v246 offset:512
    ds_read_b64_tr_b16 a[124:125], v246 offset:2048
    ds_read_b64_tr_b16 a[126:127], v246 offset:2560
    ds_read_b64_tr_b16 a[128:129], v247 offset:0
    ds_read_b64_tr_b16 a[130:131], v247 offset:512
    ds_read_b64_tr_b16 a[132:133], v247 offset:2048
    ds_read_b64_tr_b16 a[134:135], v247 offset:2560
    ds_read_b64_tr_b16 a[136:137], v246 offset:4096
    ds_read_b64_tr_b16 a[138:139], v246 offset:4608
    ds_read_b64_tr_b16 a[140:141], v246 offset:6144
    ds_read_b64_tr_b16 a[142:143], v246 offset:6656
    ds_read_b64_tr_b16 a[144:145], v247 offset:4096
    ds_read_b64_tr_b16 a[146:147], v247 offset:4608
    ds_read_b64_tr_b16 a[148:149], v247 offset:6144
    ds_read_b64_tr_b16 a[150:151], v247 offset:6656
    s_waitcnt vmcnt(23)
    ds_read_b64_tr_b16 a[152:153], v246 offset:8192
    ds_read_b64_tr_b16 a[154:155], v246 offset:8704
    ds_read_b64_tr_b16 a[156:157], v246 offset:10240
    ds_read_b64_tr_b16 a[158:159], v246 offset:10752
    ds_read_b64_tr_b16 a[160:161], v247 offset:8192
    ds_read_b64_tr_b16 a[162:163], v247 offset:8704
    ds_read_b64_tr_b16 a[164:165], v247 offset:10240
    ds_read_b64_tr_b16 a[166:167], v247 offset:10752
    s_waitcnt vmcnt(0)
    s_barrier
    s_cmp_lg_u32 s3, 0
    s_cbranch_scc1 L_f3_17
    s_lshl_b32 s60, s4, 7
    s_lshl_b32 s61, s5, 2
    s_add_u32 s60, s60, s61
    s_add_u32 s60, s60, 25600
    v_mov_b32 v10, s60
    v_mov_b32 v11, s6
    s_mov_b64 exec, 1
    s_cmp_eq_u32 s58, 0
    s_cbranch_scc1 L_f3_18
    buffer_store_dword v11, v10, s[36:39], 0 offen
    s_mov_b64 exec, -1
    s_branch L_f3_17
L_f3_18:
    buffer_store_dword v11, v10, s[36:39], 0 offen sc1
    s_mov_b64 exec, -1
L_f3_17:
L_g2:
    v_mfma_f32_32x32x16_bf16 v[128:143], a[192:195], a[0:3], 0
    v_mov_b32 v192, 0
    v_mov_b32 v193, 0
    v_mov_b32 v194, 0
    v_mfma_f32_32x32x16_bf16 v[144:159], a[200:203], a[0:3], 0
    v_mov_b32 v195, 0
    v_mov_b32 v196, 0
    v_mov_b32 v197, 0
    v_mfma_f32_32x32x16_bf16 v[128:143], a[196:199], a[4:7], v[128:143]
    v_mov_b32 v198, 0
    v_mov_b32 v199, 0
    v_mov_b32 v200, 0
    v_mfma_f32_32x32x16_bf16 v[144:159], a[204:207], a[4:7], v[144:159]
    v_mov_b32 v201, 0
    v_mov_b32 v202, 0
    v_mov_b32 v203, 0
    v_mfma_f32_32x32x16_bf16 v[128:143], a[208:211], a[8:11], v[128:143]
    v_mov_b32 v204, 0
    v_mov_b32 v205, 0
    v_mov_b32 v206, 0
    v_mfma_f32_32x32x16_bf16 v[144:159], a[216:219], a[8:11], v[144:159]
    buffer_load_dword v253, v14, s[36:39], 0 offen offset:1024 sc1
    v_mov_b32 v207, 0
    v_mfma_f32_32x32x16_bf16 v[128:143], a[212:215], a[12:15], v[128:143]
    buffer_load_short_d16_hi v192, v16, s[36:39], 0 offen offset:0 sc1
    buffer_load_short_d16_hi v193, v16, s[36:39], s52 offen offset:0 sc1
    buffer_load_short_d16_hi v194, v16, s[36:39], s54 offen offset:0 sc1
    v_mfma_f32_32x32x16_bf16 v[144:159], a[220:223], a[12:15], v[144:159]
    buffer_load_short_d16_hi v195, v16, s[36:39], s53 offen offset:0 sc1
    buffer_load_short_d16_hi v196, v12, s[36:39], 0 offen offset:0 sc1
    buffer_load_short_d16_hi v197, v12, s[36:39], s52 offen offset:0 sc1
    v_mfma_f32_32x32x16_bf16 v[128:143], a[224:227], a[16:19], v[128:143]
    buffer_load_short_d16_hi v198, v12, s[36:39], s54 offen offset:0 sc1
    buffer_load_short_d16_hi v199, v12, s[36:39], s53 offen offset:0 sc1
    buffer_load_short_d16_hi v200, v16, s[36:39], 0 offen offset:2048 sc1
    v_mfma_f32_32x32x16_bf16 v[144:159], a[232:235], a[16:19], v[144:159]
    buffer_load_short_d16_hi v201, v16, s[36:39], s52 offen offset:2048 sc1
    buffer_load_short_d16_hi v202, v16, s[36:39], s54 offen offset:2048 sc1
    buffer_load_short_d16_hi v203, v16, s[36:39], s53 offen offset:2048 sc1
    v_mfma_f32_32x32x16_bf16 v[128:143], a[228:231], a[20:23], v[128:143]
    buffer_load_short_d16_hi v204, v12, s[36:39], 0 offen offset:2048 sc1
    buffer_load_short_d16_hi v205, v12, s[36:39], s52 offen offset:2048 sc1
    buffer_load_short_d16_hi v206, v12, s[36:39], s54 offen offset:2048 sc1
    v_mfma_f32_32x32x16_bf16 v[144:159], a[236:239], a[20:23], v[144:159]
    buffer_load_short_d16_hi v207, v12, s[36:39], s53 offen offset:2048 sc1
    v_mfma_f32_32x32x16_bf16 v[128:143], a[240:243], a[24:27], v[128:143]
    v_mfma_f32_32x32x16_bf16 v[144:159], a[248:251], a[24:27], v[144:159]
    v_mfma_f32_32x32x16_bf16 v[128:143], a[244:247], a[28:31], v[128:143]
    v_mfma_f32_32x32x16_bf16 v[144:159], a[252:255], a[28:31], v[144:159]
    v_mfma_f32_32x32x16_bf16 v[128:143], v[208:211], a[32:35], v[128:143]
    s_waitcnt vmcnt(16)
    v_cmp_ne_u32 vcc, s6, v253
    s_and_b32 vcc_lo, vcc_lo, s101
    s_mov_b32 vcc_hi, 0
    s_or_b64 vcc, vcc, vcc
    s_cbranch_vccnz L_f3_1_retry
L_f3_1_ok:
    v_mfma_f32_32x32x16_bf16 v[144:159], v[216:219], a[32:35], v[144:159]
    buffer_load_dwordx4 v[32:35], v23, s[36:39], 0 offen offset:0 sc1
    buffer_load_dwordx4 v[36:39], v23, s[36:39], 0 offen offset:1024 sc1
    v_mfma_f32_32x32x16_bf16 v[128:143], v[212:215], a[36:39], v[128:143]
    v_mfma_f32_32x32x16_bf16 v[144:159], v[220:223], a[36:39], v[144:159]
    buffer_load_dwordx4 v[40:43], v23, s[36:39], 0 offen offset:2048 sc1
    s_cmp_eq_u32 s3, 3
    s_cbranch_scc1 L_s3_19
    v_mfma_f32_32x32x16_bf16 v[128:143], v[224:227], a[40:43], v[128:143]
    v_mfma_f32_32x32x16_bf16 v[144:159], v[232:235], a[40:43], v[144:159]
    v_mfma_f32_32x32x16_bf16 v[128:143], v[228:231], a[44:47], v[128:143]
    v_mfma_f32_32x32x16_bf16 v[144:159], v[236:239], a[44:47], v[144:159]
L_s3_19:
    s_waitcnt lgkmcnt(15)
    v_mfma_f32_32x32x16_bf16 v[128:143], a[88:91], a[48:51], v[128:143]
    s_waitcnt lgkmcnt(15)
    v_mfma_f32_32x32x16_bf16 v[144:159], a[96:99], a[48:51], v[144:159]
    buffer_load_dwordx4 v[44:47], v23, s[36:39], 0 offen offset:3072 sc1
    v_mfma_f32_32x32x16_bf16 v[128:143], a[92:95], a[52:55], v[128:143]
    s_waitcnt lgkmcnt(15)
    v_mfma_f32_32x32x16_bf16 v[144:159], a[100:103], a[52:55], v[144:159]
    buffer_load_dwordx4 v[48:51], v23, s[36:39], s52 offen offset:0 sc1
    s_waitcnt lgkmcnt(15)
    v_mfma_f32_32x32x16_bf16 v[128:143], a[104:107], a[56:59], v[128:143]
    buffer_load_dwordx4 v[52:55], v23, s[36:39], s52 offen offset:1024 sc1
    s_waitcnt lgkmcnt(15)
    v_mfma_f32_32x32x16_bf16 v[144:159], a[112:115], a[56:59], v[144:159]
    v_mfma_f32_32x32x16_bf16 v[128:143], a[108:111], a[60:63], v[128:143]
    buffer_load_dwordx4 v[56:59], v23, s[36:39], s52 offen offset:2048 sc1
    s_waitcnt lgkmcnt(15)
    v_mfma_f32_32x32x16_bf16 v[144:159], a[116:119], a[60:63], v[144:159]
    s_waitcnt lgkmcnt(15)
    v_mfma_f32_32x32x16_bf16 v[128:143], a[120:123], a[64:67], v[128:143]
    buffer_load_dwordx4 v[60:63], v23, s[36:39], s52 offen offset:3072 sc1
    s_waitcnt lgkmcnt(15)
    v_mfma_f32_32x32x16_bf16 v[144:159], a[128:131], a[64:67], v[144:159]
    v_mfma_f32_32x32x16_bf16 v[128:143], a[124:127], a[68:71], v[128:143]
    buffer_load_dwordx4 v[104:107], v23, s[36:39], s88 offen offset:2048 sc1
    s_waitcnt lgkmcnt(15)
    v_mfma_f32_32x32x16_bf16 v[144:159], a[132:135], a[68:71], v[144:159]
    buffer_load_dwordx4 v[108:111], v23, s[36:39], s88 offen offset:3072 sc1
    s_waitcnt lgkmcnt(14)
    v_mfma_f32_32x32x16_bf16 v[128:143], a[136:139], a[72:75], v[128:143]
    s_waitcnt lgkmcnt(10)
    v_mfma_f32_32x32x16_bf16 v[144:159], a[144:147], a[72:75], v[144:159]
    s_cmp_eq_u32 s3, 3
    s_cbranch_scc1 L_s3_21
    buffer_load_dwordx4 v[112:115], v23, s[36:39], s95 offen offset:0 sc1
    buffer_load_dwordx4 v[116:119], v23, s[36:39], s95 offen offset:1024 sc1
L_s3_21:
    v_mfma_f32_32x32x16_bf16 v[128:143], a[140:143], a[76:79], v[128:143]
    s_waitcnt lgkmcnt(8)
    v_mfma_f32_32x32x16_bf16 v[144:159], a[148:151], a[76:79], v[144:159]
    buffer_load_dwordx4 v[64:67], v23, s[36:39], s54 offen offset:0 sc1
    s_waitcnt lgkmcnt(6)
    v_mfma_f32_32x32x16_bf16 v[128:143], a[152:155], a[80:83], v[128:143]
    s_waitcnt lgkmcnt(2)
    v_mfma_f32_32x32x16_bf16 v[144:159], a[160:163], a[80:83], v[144:159]
    buffer_load_dwordx4 v[68:71], v23, s[36:39], s54 offen offset:1024 sc1
    v_mfma_f32_32x32x16_bf16 v[128:143], a[156:159], a[84:87], v[128:143]
    buffer_load_dwordx4 v[72:75], v23, s[36:39], s54 offen offset:2048 sc1
    s_waitcnt lgkmcnt(0)
    v_mfma_f32_32x32x16_bf16 v[144:159], a[164:167], a[84:87], v[144:159]
    s_waitcnt vmcnt(12)
    v_mfma_f32_32x32x16_bf16 v[160:175], a[192:195], v[32:35], 0
    buffer_load_dwordx4 v[76:79], v23, s[36:39], s54 offen offset:3072 sc1
    v_mfma_f32_32x32x16_bf16 v[176:191], a[200:203], v[32:35], 0
    s_nop 4
    ds_write_b128 v17, v[136:139] offset:0
    ds_write_b128 v17, v[140:143] offset:1024
    s_nop 0
    ds_write_b128 v21, v[144:147] offset:0
    s_waitcnt vmcnt(12)
    v_mfma_f32_32x32x16_bf16 v[160:175], a[196:199], v[36:39], v[160:175]
    buffer_load_dwordx4 v[80:83], v23, s[36:39], s53 offen offset:0 sc1
    ds_write_b128 v21, v[148:151] offset:1024
    ds_write_b128 v22, v[152:155] offset:0
    v_mfma_f32_32x32x16_bf16 v[176:191], a[204:207], v[36:39], v[176:191]
    ds_write_b128 v22, v[156:159] offset:1024
    v_add_f32 v192, v192, v128
    v_add_f32 v193, v193, v129
    s_waitcnt vmcnt(12)
    v_mfma_f32_32x32x16_bf16 v[160:175], a[208:211], v[40:43], v[160:175]
    buffer_load_dwordx4 v[84:87], v23, s[36:39], s53 offen offset:1024 sc1
    v_add_f32 v194, v194, v130
    v_add_f32 v195, v195, v131
    v_mfma_f32_32x32x16_bf16 v[176:191], a[216:219], v[40:43], v[176:191]
    buffer_load_dwordx4 v[88:91], v23, s[36:39], s53 offen offset:2048 sc1
    v_add_f32 v196, v196, v132
    v_add_f32 v197, v197, v133
    s_waitcnt vmcnt(13)
    v_mfma_f32_32x32x16_bf16 v[160:175], a[212:215], v[44:47], v[160:175]
    v_add_f32 v198, v198, v134
    v_add_f32 v199, v199, v135
    v_mfma_f32_32x32x16_bf16 v[176:191], a[220:223], v[44:47], v[176:191]
    buffer_load_dwordx4 v[92:95], v23, s[36:39], s53 offen offset:3072 sc1
    s_waitcnt vmcnt(13)
    v_mfma_f32_32x32x16_bf16 v[160:175], a[224:227], v[48:51], v[160:175]
    s_waitcnt lgkmcnt(0)
    s_barrier
    ds_read_b128 v[136:139], v18 offset:0
    ds_read_b128 v[140:143], v18 offset:1024
    ds_read_b128 v[144:147], v18 offset:2048
    v_mfma_f32_32x32x16_bf16 v[176:191], a[232:235], v[48:51], v[176:191]
    buffer_load_dwordx4 v[96:99], v23, s[36:39], s88 offen offset:0 sc1
    ds_read_b128 v[148:151], v18 offset:3072
    ds_read_b128 v[152:155], v18 offset:4096
    s_waitcnt vmcnt(13)
    v_mfma_f32_32x32x16_bf16 v[160:175], a[228:231], v[52:55], v[160:175]
    ds_read_b128 v[156:159], v18 offset:5120
    v_mfma_f32_32x32x16_bf16 v[176:191], a[236:239], v[52:55], v[176:191]
    buffer_load_dwordx4 v[100:103], v23, s[36:39], s88 offen offset:1024 sc1
    s_waitcnt vmcnt(13)
    v_mfma_f32_32x32x16_bf16 v[160:175], a[240:243], v[56:59], v[160:175]
    v_mfma_f32_32x32x16_bf16 v[176:191], a[248:251], v[56:59], v[176:191]
    s_waitcnt lgkmcnt(5)
    v_add_f32 v192, v192, v136
    v_add_f32 v193, v193, v137
    v_add_f32 v194, v194, v138
    s_waitcnt vmcnt(12)
    v_mfma_f32_32x32x16_bf16 v[160:175], a[244:247], v[60:63], v[160:175]
    v_add_f32 v195, v195, v139
    s_waitcnt lgkmcnt(4)
    v_add_f32 v196, v196, v140
    v_add_f32 v197, v197, v141
    v_mfma_f32_32x32x16_bf16 v[176:191], a[252:255], v[60:63], v[176:191]
    v_add_f32 v198, v198, v142
    v_add_f32 v199, v199, v143
    s_waitcnt lgkmcnt(3)
    v_add_f32 v192, v192, v144
    s_waitcnt vmcnt(11)
    v_mfma_f32_32x32x16_bf16 v[160:175], v[208:211], v[104:107], v[160:175]
    v_add_f32 v193, v193, v145
    v_add_f32 v194, v194, v146
    v_add_f32 v195, v195, v147
    v_mfma_f32_32x32x16_bf16 v[176:191], v[216:219], v[104:107], v[176:191]
    s_waitcnt lgkmcnt(2)
    v_add_f32 v196, v196, v148
    v_add_f32 v197, v197, v149
    v_add_f32 v198, v198, v150
    s_waitcnt vmcnt(10)
    v_mfma_f32_32x32x16_bf16 v[160:175], v[212:215], v[108:111], v[160:175]
    v_add_f32 v199, v199, v151
    s_waitcnt lgkmcnt(1)
    v_add_f32 v192, v192, v152
    v_add_f32 v193, v193, v153
    v_mfma_f32_32x32x16_bf16 v[176:191], v[220:223], v[108:111], v[176:191]
    v_add_f32 v194, v194, v154
    v_add_f32 v195, v195, v155
    s_waitcnt lgkmcnt(0)
    v_add_f32 v196, v196, v156
    s_cmp_eq_u32 s3, 3
    s_cbranch_scc1 L_s3_20
    s_waitcnt vmcnt(11)
    s_waitcnt vmcnt(11)
    v_mfma_f32_32x32x16_bf16 v[160:175], v[224:227], v[112:115], v[160:175]
    s_waitcnt vmcnt(11)
    v_mfma_f32_32x32x16_bf16 v[176:191], v[232:235], v[112:115], v[176:191]
    s_waitcnt vmcnt(10)
    s_waitcnt vmcnt(10)
    v_mfma_f32_32x32x16_bf16 v[160:175], v[228:231], v[116:119], v[160:175]
    s_waitcnt vmcnt(10)
    v_mfma_f32_32x32x16_bf16 v[176:191], v[236:239], v[116:119], v[176:191]
L_s3_20:
    s_waitcnt vmcnt(9)
    v_mfma_f32_32x32x16_bf16 v[160:175], a[88:91], v[64:67], v[160:175]
    v_add_f32 v197, v197, v157
    v_add_f32 v198, v198, v158
    v_add_f32 v199, v199, v159
    v_mfma_f32_32x32x16_bf16 v[176:191], a[96:99], v[64:67], v[176:191]
    v_cvt_pk_bf16_f32 v128, v192, v193
    v_cvt_pk_bf16_f32 v129, v194, v195
    v_cvt_pk_bf16_f32 v130, v196, v197
    s_waitcnt vmcnt(8)
    v_mfma_f32_32x32x16_bf16 v[160:175], a[92:95], v[68:71], v[160:175]
    v_cvt_pk_bf16_f32 v131, v198, v199
    v_mfma_f32_32x32x16_bf16 v[176:191], a[100:103], v[68:71], v[176:191]
    s_mov_b32 s51, 0
    buffer_store_dwordx4 v[128:131], v19, s[32:35], s51 offen
    s_waitcnt vmcnt(8)
    v_mfma_f32_32x32x16_bf16 v[160:175], a[104:107], v[72:75], v[160:175]
    v_mfma_f32_32x32x16_bf16 v[176:191], a[112:115], v[72:75], v[176:191]
    s_waitcnt vmcnt(7)
    v_mfma_f32_32x32x16_bf16 v[160:175], a[108:111], v[76:79], v[160:175]
    v_mfma_f32_32x32x16_bf16 v[176:191], a[116:119], v[76:79], v[176:191]
    s_waitcnt vmcnt(6)
    v_mfma_f32_32x32x16_bf16 v[160:175], a[120:123], v[80:83], v[160:175]
    v_mfma_f32_32x32x16_bf16 v[176:191], a[128:131], v[80:83], v[176:191]
    s_waitcnt vmcnt(5)
    v_mfma_f32_32x32x16_bf16 v[160:175], a[124:127], v[84:87], v[160:175]
    v_mfma_f32_32x32x16_bf16 v[176:191], a[132:135], v[84:87], v[176:191]
    s_waitcnt vmcnt(4)
    v_mfma_f32_32x32x16_bf16 v[160:175], a[136:139], v[88:91], v[160:175]
    v_mfma_f32_32x32x16_bf16 v[176:191], a[144:147], v[88:91], v[176:191]
    s_waitcnt vmcnt(3)
    v_mfma_f32_32x32x16_bf16 v[160:175], a[140:143], v[92:95], v[160:175]
    v_mfma_f32_32x32x16_bf16 v[176:191], a[148:151], v[92:95], v[176:191]
    s_waitcnt vmcnt(2)
    v_mfma_f32_32x32x16_bf16 v[160:175], a[152:155], v[96:99], v[160:175]
    v_mfma_f32_32x32x16_bf16 v[176:191], a[160:163], v[96:99], v[176:191]
    s_waitcnt vmcnt(1)
    v_mfma_f32_32x32x16_bf16 v[160:175], a[156:159], v[100:103], v[160:175]
    v_mfma_f32_32x32x16_bf16 v[176:191], a[164:167], v[100:103], v[176:191]
    s_nop 10
    ds_write_b128 v17, v[168:171] offset:32768
    ds_write_b128 v17, v[172:175] offset:33792
    ds_write_b128 v21, v[176:179] offset:32768
    ds_write_b128 v21, v[180:183] offset:33792
    ds_write_b128 v22, v[184:187] offset:32768
    ds_write_b128 v22, v[188:191] offset:33792
    v_pk_add_f32 v[200:201], v[200:201], v[160:161]
    v_pk_add_f32 v[202:203], v[202:203], v[162:163]
    v_pk_add_f32 v[204:205], v[204:205], v[164:165]
    v_pk_add_f32 v[206:207], v[206:207], v[166:167]
    s_waitcnt lgkmcnt(0)
    s_barrier
    ds_read_b128 v[168:171], v18 offset:32768
    ds_read_b128 v[172:175], v18 offset:33792
    ds_read_b128 v[176:179], v18 offset:34816
    ds_read_b128 v[180:183], v18 offset:35840
    ds_read_b128 v[184:187], v18 offset:36864
    ds_read_b128 v[188:191], v18 offset:37888
    s_waitcnt lgkmcnt(5)
    v_pk_add_f32 v[200:201], v[200:201], v[168:169]
    v_pk_add_f32 v[202:203], v[202:203], v[170:171]
    s_waitcnt lgkmcnt(4)
    v_pk_add_f32 v[204:205], v[204:205], v[172:173]
    v_pk_add_f32 v[206:207], v[206:207], v[174:175]
    s_waitcnt lgkmcnt(3)
    v_pk_add_f32 v[200:201], v[200:201], v[176:177]
    v_pk_add_f32 v[202:203], v[202:203], v[178:179]
    s_waitcnt lgkmcnt(2)
    v_pk_add_f32 v[204:205], v[204:205], v[180:181]
    v_pk_add_f32 v[206:207], v[206:207], v[182:183]
    s_waitcnt lgkmcnt(1)
    v_pk_add_f32 v[200:201], v[200:201], v[184:185]
    v_pk_add_f32 v[202:203], v[202:203], v[186:187]
    s_waitcnt lgkmcnt(0)
    v_pk_add_f32 v[204:205], v[204:205], v[188:189]
    v_pk_add_f32 v[206:207], v[206:207], v[190:191]
    v_cvt_pk_bf16_f32 v160, v200, v201
    v_cvt_pk_bf16_f32 v161, v202, v203
    v_cvt_pk_bf16_f32 v162, v204, v205
    v_cvt_pk_bf16_f32 v163, v206, v207
    s_mov_b32 s51, 1048576
    buffer_store_dwordx4 v[160:163], v19, s[32:35], s51 offen
L_fin:
L_end:
    s_endpgm
L_hot_end:
L_stats:
    s_waitcnt vmcnt(0) lgkmcnt(0)
    s_lshl_b32 s60, s3, 5
    v_xor_b32 v6, s60, v28
    s_lshl_b32 s60, s3, 8
    v_add_u32 v7, s60, v251
    s_movk_i32 s51, 0
    buffer_load_dword v253, v252, s[36:39], s51 offen sc1
    s_waitcnt vmcnt(0)
    v_cmp_ne_u32 vcc, 16, v253
    s_cbranch_vccnz L_cnt0s_retry
L_cnt0s_ok:
    s_add_u32 m0, s45, 0
    s_mov_b32 s44, 0
    buffer_load_dwordx4 v24, s[36:39], s44 offen offset:0 sc1 lds
    buffer_load_dwordx4 v25, s[36:39], s44 offen offset:1024 sc1 lds
    buffer_load_dwordx4 v26, s[36:39], s44 offen offset:2048 sc1 lds
    buffer_load_dwordx4 v27, s[36:39], s44 offen offset:3072 sc1 lds
    s_add_u32 m0, s45, 16384
    s_mov_b32 s44, 524288
    buffer_load_dwordx4 v24, s[36:39], s44 offen offset:0 sc1 lds
    buffer_load_dwordx4 v25, s[36:39], s44 offen offset:1024 sc1 lds
    buffer_load_dwordx4 v26, s[36:39], s44 offen offset:2048 sc1 lds
    buffer_load_dwordx4 v27, s[36:39], s44 offen offset:3072 sc1 lds
    s_add_u32 m0, s45, 32768
    s_mov_b32 s44, 1048576
    buffer_load_dwordx4 v24, s[36:39], s44 offen offset:0 sc1 lds
    buffer_load_dwordx4 v25, s[36:39], s44 offen offset:1024 sc1 lds
    buffer_load_dwordx4 v26, s[36:39], s44 offen offset:2048 sc1 lds
    buffer_load_dwordx4 v27, s[36:39], s44 offen offset:3072 sc1 lds
    s_add_u32 m0, s45, 49152
    s_mov_b32 s44, 1572864
    buffer_load_dwordx4 v24, s[36:39], s44 offen offset:0 sc1 lds
    buffer_load_dwordx4 v25, s[36:39], s44 offen offset:1024 sc1 lds
    buffer_load_dwordx4 v26, s[36:39], s44 offen offset:2048 sc1 lds
    buffer_load_dwordx4 v27, s[36:39], s44 offen offset:3072 sc1 lds
    s_mul_i32 s60, s2, 1408
    s_min_u32 s60, s60, 350848
    v_add_u32 v10, s60, v0
    s_cmp_eq_u32 s3, 1
    s_cselect_b32 s66, s28, s24
    s_cselect_b32 s67, s29, s25
    s_cselect_b32 s60, 1, 0
    s_cmp_eq_u32 s3, 3
    s_cselect_b32 s60, 0, s60
    s_cmp_eq_u32 s60, 0
    s_cbranch_scc1 L_mp_22
    s_mov_b32 exec_lo, 0x0
    s_mov_b32 exec_hi, 0x0
    s_cmp_eq_u32 s3, 1
    s_cselect_b32 exec_lo, -1, exec_lo
    s_cselect_b32 exec_hi, 0xfff, exec_hi
    global_load_dword v255, v10, s[66:67]
    s_mov_b64 exec, -1
L_mp_22:
    s_add_u32 m0, s47, 131072
    s_mov_b32 s44, 0
    buffer_load_dwordx4 v240, s[28:31], s44 offen offset:0 lds
    buffer_load_dwordx4 v241, s[28:31], s44 offen offset:1024 lds
    buffer_load_dwordx4 v242, s[28:31], s44 offen offset:2048 lds
    buffer_load_dwordx4 v243, s[28:31], s44 offen offset:3072 lds
    s_add_u32 m0, s47, 135168
    s_mov_b32 s44, 32768
    buffer_load_dwordx4 v240, s[28:31], s44 offen offset:0 lds
    buffer_load_dwordx4 v241, s[28:31], s44 offen offset:1024 lds
    buffer_load_dwordx4 v242, s[28:31], s44 offen offset:2048 lds
    buffer_load_dwordx4 v243, s[28:31], s44 offen offset:3072 lds
    v_mov_b32 v176, 0
    v_mov_b32 v177, 0
    v_mov_b32 v178, 0
    v_mov_b32 v179, 0
    s_waitcnt vmcnt(20)
    s_barrier
    ds_read_b64_tr_b16 v[128:129], v6 offset:0
    ds_read_b64_tr_b16 v[130:131], v6 offset:2048
    ds_read_b64_tr_b16 v[132:133], v6 offset:4096
    ds_read_b64_tr_b16 v[134:135], v6 offset:6144
    ds_read_b64_tr_b16 v[136:137], v6 offset:8192
    ds_read_b64_tr_b16 v[138:139], v6 offset:10240
    ds_read_b64_tr_b16 v[140:141], v6 offset:12288
    ds_read_b64_tr_b16 v[142:143], v6 offset:14336
    s_waitcnt lgkmcnt(7)
    v_dot2c_f32_bf16 v176, s100, v128
    v_dot2c_f32_bf16 v177, v128, v128
    v_dot2c_f32_bf16 v178, s100, v129
    v_dot2c_f32_bf16 v179, v129, v129
    s_waitcnt lgkmcnt(6)
    v_dot2c_f32_bf16 v176, s100, v130
    v_dot2c_f32_bf16 v177, v130, v130
    v_dot2c_f32_bf16 v178, s100, v131
    v_dot2c_f32_bf16 v179, v131, v131
    s_waitcnt lgkmcnt(5)
    v_dot2c_f32_bf16 v176, s100, v132
    v_dot2c_f32_bf16 v177, v132, v132
    v_dot2c_f32_bf16 v178, s100, v133
    v_dot2c_f32_bf16 v179, v133, v133
    s_waitcnt lgkmcnt(4)
    v_dot2c_f32_bf16 v176, s100, v134
    v_dot2c_f32_bf16 v177, v134, v134
    v_dot2c_f32_bf16 v178, s100, v135
    v_dot2c_f32_bf16 v179, v135, v135
    s_waitcnt lgkmcnt(3)
    v_dot2c_f32_bf16 v176, s100, v136
    v_dot2c_f32_bf16 v177, v136, v136
    v_dot2c_f32_bf16 v178, s100, v137
    v_dot2c_f32_bf16 v179, v137, v137
    s_waitcnt lgkmcnt(2)
    v_dot2c_f32_bf16 v176, s100, v138
    v_dot2c_f32_bf16 v177, v138, v138
    v_dot2c_f32_bf16 v178, s100, v139
    v_dot2c_f32_bf16 v179, v139, v139
    s_waitcnt lgkmcnt(1)
    v_dot2c_f32_bf16 v176, s100, v140
    v_dot2c_f32_bf16 v177, v140, v140
    v_dot2c_f32_bf16 v178, s100, v141
    v_dot2c_f32_bf16 v179, v141, v141
    s_waitcnt lgkmcnt(0)
    v_dot2c_f32_bf16 v176, s100, v142
    v_dot2c_f32_bf16 v177, v142, v142
    v_dot2c_f32_bf16 v178, s100, v143
    v_dot2c_f32_bf16 v179, v143, v143
    s_waitcnt vmcnt(16)
    s_barrier
    ds_read_b64_tr_b16 v[128:129], v6 offset:16384
    ds_read_b64_tr_b16 v[130:131], v6 offset:18432
    ds_read_b64_tr_b16 v[132:133], v6 offset:20480
    ds_read_b64_tr_b16 v[134:135], v6 offset:22528
    ds_read_b64_tr_b16 v[136:137], v6 offset:24576
    ds_read_b64_tr_b16 v[138:139], v6 offset:26624
    ds_read_b64_tr_b16 v[140:141], v6 offset:28672
    ds_read_b64_tr_b16 v[142:143], v6 offset:30720
    s_waitcnt lgkmcnt(7)
    v_dot2c_f32_bf16 v176, s100, v128
    v_dot2c_f32_bf16 v177, v128, v128
    v_dot2c_f32_bf16 v178, s100, v129
    v_dot2c_f32_bf16 v179, v129, v129
    s_waitcnt lgkmcnt(6)
    v_dot2c_f32_bf16 v176, s100, v130
    v_dot2c_f32_bf16 v177, v130, v130
    v_dot2c_f32_bf16 v178, s100, v131
    v_dot2c_f32_bf16 v179, v131, v131
    s_waitcnt lgkmcnt(5)
    v_dot2c_f32_bf16 v176, s100, v132
    v_dot2c_f32_bf16 v177, v132, v132
    v_dot2c_f32_bf16 v178, s100, v133
    v_dot2c_f32_bf16 v179, v133, v133
    s_waitcnt lgkmcnt(4)
    v_dot2c_f32_bf16 v176, s100, v134
    v_dot2c_f32_bf16 v177, v134, v134
    v_dot2c_f32_bf16 v178, s100, v135
    v_dot2c_f32_bf16 v179, v135, v135
    s_waitcnt lgkmcnt(3)
    v_dot2c_f32_bf16 v176, s100, v136
    v_dot2c_f32_bf16 v177, v136, v136
    v_dot2c_f32_bf16 v178, s100, v137
    v_dot2c_f32_bf16 v179, v137, v137
    s_waitcnt lgkmcnt(2)
    v_dot2c_f32_bf16 v176, s100, v138
    v_dot2c_f32_bf16 v177, v138, v138
    v_dot2c_f32_bf16 v178, s100, v139
    v_dot2c_f32_bf16 v179, v139, v139
    s_waitcnt lgkmcnt(1)
    v_dot2c_f32_bf16 v176, s100, v140
    v_dot2c_f32_bf16 v177, v140, v140
    v_dot2c_f32_bf16 v178, s100, v141
    v_dot2c_f32_bf16 v179, v141, v141
    s_waitcnt lgkmcnt(0)
    v_dot2c_f32_bf16 v176, s100, v142
    v_dot2c_f32_bf16 v177, v142, v142
    v_dot2c_f32_bf16 v178, s100, v143
    v_dot2c_f32_bf16 v179, v143, v143
    s_waitcnt vmcnt(12)
    s_barrier
    ds_read_b64_tr_b16 v[128:129], v6 offset:32768
    ds_read_b64_tr_b16 v[130:131], v6 offset:34816
    ds_read_b64_tr_b16 v[132:133], v6 offset:36864
    ds_read_b64_tr_b16 v[134:135], v6 offset:38912
    ds_read_b64_tr_b16 v[136:137], v6 offset:40960
    ds_read_b64_tr_b16 v[138:139], v6 offset:43008
    ds_read_b64_tr_b16 v[140:141], v6 offset:45056
    ds_read_b64_tr_b16 v[142:143], v6 offset:47104
    s_waitcnt lgkmcnt(7)
    v_dot2c_f32_bf16 v176, s100, v128
    v_dot2c_f32_bf16 v177, v128, v128
    v_dot2c_f32_bf16 v178, s100, v129
    v_dot2c_f32_bf16 v179, v129, v129
    s_waitcnt lgkmcnt(6)
    v_dot2c_f32_bf16 v176, s100, v130
    v_dot2c_f32_bf16 v177, v130, v130
    v_dot2c_f32_bf16 v178, s100, v131
    v_dot2c_f32_bf16 v179, v131, v131
    s_waitcnt lgkmcnt(5)
    v_dot2c_f32_bf16 v176, s100, v132
    v_dot2c_f32_bf16 v177, v132, v132
    v_dot2c_f32_bf16 v178, s100, v133
    v_dot2c_f32_bf16 v179, v133, v133
    s_waitcnt lgkmcnt(4)
    v_dot2c_f32_bf16 v176, s100, v134
    v_dot2c_f32_bf16 v177, v134, v134
    v_dot2c_f32_bf16 v178, s100, v135
    v_dot2c_f32_bf16 v179, v135, v135
    s_waitcnt lgkmcnt(3)
    v_dot2c_f32_bf16 v176, s100, v136
    v_dot2c_f32_bf16 v177, v136, v136
    v_dot2c_f32_bf16 v178, s100, v137
    v_dot2c_f32_bf16 v179, v137, v137
    s_waitcnt lgkmcnt(2)
    v_dot2c_f32_bf16 v176, s100, v138
    v_dot2c_f32_bf16 v177, v138, v138
    v_dot2c_f32_bf16 v178, s100, v139
    v_dot2c_f32_bf16 v179, v139, v139
    s_waitcnt lgkmcnt(1)
    v_dot2c_f32_bf16 v176, s100, v140
    v_dot2c_f32_bf16 v177, v140, v140
    v_dot2c_f32_bf16 v178, s100, v141
    v_dot2c_f32_bf16 v179, v141, v141
    s_waitcnt lgkmcnt(0)
    v_dot2c_f32_bf16 v176, s100, v142
    v_dot2c_f32_bf16 v177, v142, v142
    v_dot2c_f32_bf16 v178, s100, v143
    v_dot2c_f32_bf16 v179, v143, v143
    s_waitcnt vmcnt(8)
    s_barrier
    ds_read_b64_tr_b16 v[128:129], v6 offset:49152
    ds_read_b64_tr_b16 v[130:131], v6 offset:51200
    ds_read_b64_tr_b16 v[132:133], v6 offset:53248
    ds_read_b64_tr_b16 v[134:135], v6 offset:55296
    ds_read_b64_tr_b16 v[136:137], v6 offset:57344
    ds_read_b64_tr_b16 v[138:139], v6 offset:59392
    ds_read_b64_tr_b16 v[140:141], v6 offset:61440
    ds_read_b64_tr_b16 v[142:143], v6 offset:63488
    s_waitcnt lgkmcnt(7)
    v_dot2c_f32_bf16 v176, s100, v128
    v_dot2c_f32_bf16 v177, v128, v128
    v_dot2c_f32_bf16 v178, s100, v129
    v_dot2c_f32_bf16 v179, v129, v129
    s_waitcnt lgkmcnt(6)
    v_dot2c_f32_bf16 v176, s100, v130
    v_dot2c_f32_bf16 v177, v130, v130
    v_dot2c_f32_bf16 v178, s100, v131
    v_dot2c_f32_bf16 v179, v131, v131
    s_waitcnt lgkmcnt(5)
    v_dot2c_f32_bf16 v176, s100, v132
    v_dot2c_f32_bf16 v177, v132, v132
    v_dot2c_f32_bf16 v178, s100, v133
    v_dot2c_f32_bf16 v179, v133, v133
    s_waitcnt lgkmcnt(4)
    v_dot2c_f32_bf16 v176, s100, v134
    v_dot2c_f32_bf16 v177, v134, v134
    v_dot2c_f32_bf16 v178, s100, v135
    v_dot2c_f32_bf16 v179, v135, v135
    s_waitcnt lgkmcnt(3)
    v_dot2c_f32_bf16 v176, s100, v136
    v_dot2c_f32_bf16 v177, v136, v136
    v_dot2c_f32_bf16 v178, s100, v137
    v_dot2c_f32_bf16 v179, v137, v137
    s_waitcnt lgkmcnt(2)
    v_dot2c_f32_bf16 v176, s100, v138
    v_dot2c_f32_bf16 v177, v138, v138
    v_dot2c_f32_bf16 v178, s100, v139
    v_dot2c_f32_bf16 v179, v139, v139
    s_waitcnt lgkmcnt(1)
    v_dot2c_f32_bf16 v176, s100, v140
    v_dot2c_f32_bf16 v177, v140, v140
    v_dot2c_f32_bf16 v178, s100, v141
    v_dot2c_f32_bf16 v179, v141, v141
    s_waitcnt lgkmcnt(0)
    v_dot2c_f32_bf16 v176, s100, v142
    v_dot2c_f32_bf16 v177, v142, v142
    v_dot2c_f32_bf16 v178, s100, v143
    v_dot2c_f32_bf16 v179, v143, v143
    s_nop 1
    v_add_f32 v176, v176, v178
    v_add_f32 v177, v177, v179
    v_mov_b32 v180, v176
    v_mov_b32 v181, v177
    s_nop 0
    v_permlane32_swap_b32 v180, v176
    v_permlane32_swap_b32 v181, v177
    v_add_f32 v176, v176, v180
    v_add_f32 v177, v177, v181
    v_mov_b32 v180, v176
    v_mov_b32 v181, v177
    s_nop 0
    v_permlane16_swap_b32 v180, v176
    v_permlane16_swap_b32 v181, v177
    v_add_f32 v176, v176, v180
    v_add_f32 v177, v177, v181
    v_mov_b32 v178, v176
    v_mov_b32 v179, v177
    s_mov_b32 s60, 0x3b000000
    v_mul_f32 v176, s60, v176
    v_mul_f32 v177, s60, v177
    v_mul_f32 v178, s60, v178
    v_mul_f32 v179, s60, v179
    v_fma_f32 v177, -v176, v176, v177
    v_fma_f32 v179, -v178, v178, v179
    v_max_f32 v177, 0, v177
    v_max_f32 v179, 0, v179
    v_cvt_pk_bf16_f32 v180, v177, v179
    s_mov_b32 s60, 0x3727c5ac
    v_lshlrev_b32 v182, 16, v180
    v_and_b32 v183, 0xffff0000, v180
    v_add_f32 v182, s60, v182
    v_add_f32 v183, s60, v183
    v_cvt_pk_bf16_f32 v180, v182, v183
    v_lshlrev_b32 v182, 16, v180
    v_and_b32 v183, 0xffff0000, v180
    v_sqrt_f32 v182, v182
    v_sqrt_f32 v183, v183
    v_cvt_pk_bf16_f32 v180, v176, v182
    v_lshlrev_b32 v184, 16, v180
    v_and_b32 v185, 0xffff0000, v180
    v_mov_b32 v186, s6
    v_mov_b32 v187, s7
    s_movk_i32 s60, 0
    s_mov_b64 exec, 0xffff
    buffer_store_dwordx4 v[184:187], v7, s[36:39], s60 offen sc1
    s_mov_b64 exec, -1
    v_add_u32 v6, 65536, v6
    s_waitcnt vmcnt(5)
    ds_read_b64_tr_b16 a[192:193], v244 offset:32768
    ds_read_b64_tr_b16 a[194:195], v244 offset:33280
    ds_read_b64_tr_b16 a[196:197], v244 offset:34816
    ds_read_b64_tr_b16 a[198:199], v244 offset:35328
    ds_read_b64_tr_b16 a[200:201], v245 offset:32768
    ds_read_b64_tr_b16 a[202:203], v245 offset:33280
    ds_read_b64_tr_b16 a[204:205], v245 offset:34816
    ds_read_b64_tr_b16 a[206:207], v245 offset:35328
    s_waitcnt vmcnt(1)
    ds_read_b64_tr_b16 a[208:209], v244 offset:36864
    ds_read_b64_tr_b16 a[210:211], v244 offset:37376
    ds_read_b64_tr_b16 a[212:213], v244 offset:38912
    ds_read_b64_tr_b16 a[214:215], v244 offset:39424
    ds_read_b64_tr_b16 a[216:217], v245 offset:36864
    ds_read_b64_tr_b16 a[218:219], v245 offset:37376
    ds_read_b64_tr_b16 a[220:221], v245 offset:38912
    ds_read_b64_tr_b16 a[222:223], v245 offset:39424
    s_waitcnt lgkmcnt(0)
    s_add_u32 m0, s47, 131072
    s_mov_b32 s44, 131072
    buffer_load_dwordx4 v240, s[28:31], s44 offen offset:0 lds
    buffer_load_dwordx4 v241, s[28:31], s44 offen offset:1024 lds
    buffer_load_dwordx4 v242, s[28:31], s44 offen offset:2048 lds
    buffer_load_dwordx4 v243, s[28:31], s44 offen offset:3072 lds
    s_add_u32 m0, s47, 135168
    s_mov_b32 s44, 163840
    buffer_load_dwordx4 v240, s[28:31], s44 offen offset:0 lds
    buffer_load_dwordx4 v241, s[28:31], s44 offen offset:1024 lds
    buffer_load_dwordx4 v242, s[28:31], s44 offen offset:2048 lds
    buffer_load_dwordx4 v243, s[28:31], s44 offen offset:3072 lds
    s_waitcnt lgkmcnt(0)
    s_barrier
    s_add_u32 m0, s57, 0
    s_mov_b32 s44, 65536
    buffer_load_dwordx4 v240, s[28:31], s44 offen offset:0 lds
    buffer_load_dwordx4 v241, s[28:31], s44 offen offset:1024 lds
    buffer_load_dwordx4 v242, s[28:31], s44 offen offset:2048 lds
    buffer_load_dwordx4 v243, s[28:31], s44 offen offset:3072 lds
    s_add_u32 m0, s57, 4096
    s_mov_b32 s44, 98304
    buffer_load_dwordx4 v240, s[28:31], s44 offen offset:0 lds
    buffer_load_dwordx4 v241, s[28:31], s44 offen offset:1024 lds
    buffer_load_dwordx4 v242, s[28:31], s44 offen offset:2048 lds
    buffer_load_dwordx4 v243, s[28:31], s44 offen offset:3072 lds
    s_add_u32 m0, s57, 8192
    s_mov_b32 s44, 294912
    buffer_load_dwordx4 v240, s[28:31], s44 offen offset:0 lds
    buffer_load_dwordx4 v241, s[28:31], s44 offen offset:1024 lds
    buffer_load_dwordx4 v242, s[28:31], s44 offen offset:2048 lds
    buffer_load_dwordx4 v243, s[28:31], s44 offen offset:3072 lds
    s_add_u32 m0, s57, 12288
    s_mov_b32 s44, 327680
    buffer_load_dwordx4 v240, s[28:31], s44 offen offset:0 lds
    buffer_load_dwordx4 v241, s[28:31], s44 offen offset:1024 lds
    buffer_load_dwordx4 v242, s[28:31], s44 offen offset:2048 lds
    buffer_load_dwordx4 v243, s[28:31], s44 offen offset:3072 lds
    s_movk_i32 s51, 16384
    buffer_load_dword v253, v252, s[36:39], s51 offen sc1
    s_waitcnt vmcnt(0)
    v_cmp_ne_u32 vcc, 16, v253
    s_cbranch_vccnz L_cnt1s_retry
L_cnt1s_ok:
    s_add_u32 m0, s45, 65536
    s_mov_b32 s44, 2048
    buffer_load_dwordx4 v24, s[36:39], s44 offen offset:0 sc1 lds
    buffer_load_dwordx4 v25, s[36:39], s44 offen offset:1024 sc1 lds
    buffer_load_dwordx4 v26, s[36:39], s44 offen offset:2048 sc1 lds
    buffer_load_dwordx4 v27, s[36:39], s44 offen offset:3072 sc1 lds
    s_add_u32 m0, s45, 81920
    s_mov_b32 s44, 526336
    buffer_load_dwordx4 v24, s[36:39], s44 offen offset:0 sc1 lds
    buffer_load_dwordx4 v25, s[36:39], s44 offen offset:1024 sc1 lds
    buffer_load_dwordx4 v26, s[36:39], s44 offen offset:2048 sc1 lds
    buffer_load_dwordx4 v27, s[36:39], s44 offen offset:3072 sc1 lds
    s_add_u32 m0, s45, 98304
    s_mov_b32 s44, 1050624
    buffer_load_dwordx4 v24, s[36:39], s44 offen offset:0 sc1 lds
    buffer_load_dwordx4 v25, s[36:39], s44 offen offset:1024 sc1 lds
    buffer_load_dwordx4 v26, s[36:39], s44 offen offset:2048 sc1 lds
    buffer_load_dwordx4 v27, s[36:39], s44 offen offset:3072 sc1 lds
    s_add_u32 m0, s45, 114688
    s_mov_b32 s44, 1574912
    buffer_load_dwordx4 v24, s[36:39], s44 offen offset:0 sc1 lds
    buffer_load_dwordx4 v25, s[36:39], s44 offen offset:1024 sc1 lds
    buffer_load_dwordx4 v26, s[36:39], s44 offen offset:2048 sc1 lds
    buffer_load_dwordx4 v27, s[36:39], s44 offen offset:3072 sc1 lds
    v_mov_b32 v176, 0
    v_mov_b32 v177, 0
    v_mov_b32 v178, 0
    v_mov_b32 v179, 0
    s_waitcnt vmcnt(12)
    s_barrier
    ds_read_b64_tr_b16 v[128:129], v6 offset:0
    ds_read_b64_tr_b16 v[130:131], v6 offset:2048
    ds_read_b64_tr_b16 v[132:133], v6 offset:4096
    ds_read_b64_tr_b16 v[134:135], v6 offset:6144
    ds_read_b64_tr_b16 v[136:137], v6 offset:8192
    ds_read_b64_tr_b16 v[138:139], v6 offset:10240
    ds_read_b64_tr_b16 v[140:141], v6 offset:12288
    ds_read_b64_tr_b16 v[142:143], v6 offset:14336
    s_waitcnt lgkmcnt(7)
    v_dot2c_f32_bf16 v176, s100, v128
    v_dot2c_f32_bf16 v177, v128, v128
    v_dot2c_f32_bf16 v178, s100, v129
    v_dot2c_f32_bf16 v179, v129, v129
    s_waitcnt lgkmcnt(6)
    v_dot2c_f32_bf16 v176, s100, v130
    v_dot2c_f32_bf16 v177, v130, v130
    v_dot2c_f32_bf16 v178, s100, v131
    v_dot2c_f32_bf16 v179, v131, v131
    s_waitcnt lgkmcnt(5)
    v_dot2c_f32_bf16 v176, s100, v132
    v_dot2c_f32_bf16 v177, v132, v132
    v_dot2c_f32_bf16 v178, s100, v133
    v_dot2c_f32_bf16 v179, v133, v133
    s_waitcnt lgkmcnt(4)
    v_dot2c_f32_bf16 v176, s100, v134
    v_dot2c_f32_bf16 v177, v134, v134
    v_dot2c_f32_bf16 v178, s100, v135
    v_dot2c_f32_bf16 v179, v135, v135
    s_waitcnt lgkmcnt(3)
    v_dot2c_f32_bf16 v176, s100, v136
    v_dot2c_f32_bf16 v177, v136, v136
    v_dot2c_f32_bf16 v178, s100, v137
    v_dot2c_f32_bf16 v179, v137, v137
    s_waitcnt lgkmcnt(2)
    v_dot2c_f32_bf16 v176, s100, v138
    v_dot2c_f32_bf16 v177, v138, v138
    v_dot2c_f32_bf16 v178, s100, v139
    v_dot2c_f32_bf16 v179, v139, v139
    s_waitcnt lgkmcnt(1)
    v_dot2c_f32_bf16 v176, s100, v140
    v_dot2c_f32_bf16 v177, v140, v140
    v_dot2c_f32_bf16 v178, s100, v141
    v_dot2c_f32_bf16 v179, v141, v141
    s_waitcnt lgkmcnt(0)
    v_dot2c_f32_bf16 v176, s100, v142
    v_dot2c_f32_bf16 v177, v142, v142
    v_dot2c_f32_bf16 v178, s100, v143
    v_dot2c_f32_bf16 v179, v143, v143
    s_waitcnt vmcnt(8)
    s_barrier
    ds_read_b64_tr_b16 v[128:129], v6 offset:16384
    ds_read_b64_tr_b16 v[130:131], v6 offset:18432
    ds_read_b64_tr_b16 v[132:133], v6 offset:20480
    ds_read_b64_tr_b16 v[134:135], v6 offset:22528
    ds_read_b64_tr_b16 v[136:137], v6 offset:24576
    ds_read_b64_tr_b16 v[138:139], v6 offset:26624
    ds_read_b64_tr_b16 v[140:141], v6 offset:28672
    ds_read_b64_tr_b16 v[142:143], v6 offset:30720
    s_waitcnt lgkmcnt(7)
    v_dot2c_f32_bf16 v176, s100, v128
    v_dot2c_f32_bf16 v177, v128, v128
    v_dot2c_f32_bf16 v178, s100, v129
    v_dot2c_f32_bf16 v179, v129, v129
    s_waitcnt lgkmcnt(6)
    v_dot2c_f32_bf16 v176, s100, v130
    v_dot2c_f32_bf16 v177, v130, v130
    v_dot2c_f32_bf16 v178, s100, v131
    v_dot2c_f32_bf16 v179, v131, v131
    s_waitcnt lgkmcnt(5)
    v_dot2c_f32_bf16 v176, s100, v132
    v_dot2c_f32_bf16 v177, v132, v132
    v_dot2c_f32_bf16 v178, s100, v133
    v_dot2c_f32_bf16 v179, v133, v133
    s_waitcnt lgkmcnt(4)
    v_dot2c_f32_bf16 v176, s100, v134
    v_dot2c_f32_bf16 v177, v134, v134
    v_dot2c_f32_bf16 v178, s100, v135
    v_dot2c_f32_bf16 v179, v135, v135
    s_waitcnt lgkmcnt(3)
    v_dot2c_f32_bf16 v176, s100, v136
    v_dot2c_f32_bf16 v177, v136, v136
    v_dot2c_f32_bf16 v178, s100, v137
    v_dot2c_f32_bf16 v179, v137, v137
    s_waitcnt lgkmcnt(2)
    v_dot2c_f32_bf16 v176, s100, v138
    v_dot2c_f32_bf16 v177, v138, v138
    v_dot2c_f32_bf16 v178, s100, v139
    v_dot2c_f32_bf16 v179, v139, v139
    s_waitcnt lgkmcnt(1)
    v_dot2c_f32_bf16 v176, s100, v140
    v_dot2c_f32_bf16 v177, v140, v140
    v_dot2c_f32_bf16 v178, s100, v141
    v_dot2c_f32_bf16 v179, v141, v141
    s_waitcnt lgkmcnt(0)
    v_dot2c_f32_bf16 v176, s100, v142
    v_dot2c_f32_bf16 v177, v142, v142
    v_dot2c_f32_bf16 v178, s100, v143
    v_dot2c_f32_bf16 v179, v143, v143
    s_waitcnt vmcnt(4)
    s_barrier
    ds_read_b64_tr_b16 v[128:129], v6 offset:32768
    ds_read_b64_tr_b16 v[130:131], v6 offset:34816
    ds_read_b64_tr_b16 v[132:133], v6 offset:36864
    ds_read_b64_tr_b16 v[134:135], v6 offset:38912
    ds_read_b64_tr_b16 v[136:137], v6 offset:40960
    ds_read_b64_tr_b16 v[138:139], v6 offset:43008
    ds_read_b64_tr_b16 v[140:141], v6 offset:45056
    ds_read_b64_tr_b16 v[142:143], v6 offset:47104
    s_waitcnt lgkmcnt(7)
    v_dot2c_f32_bf16 v176, s100, v128
    v_dot2c_f32_bf16 v177, v128, v128
    v_dot2c_f32_bf16 v178, s100, v129
    v_dot2c_f32_bf16 v179, v129, v129
    s_waitcnt lgkmcnt(6)
    v_dot2c_f32_bf16 v176, s100, v130
    v_dot2c_f32_bf16 v177, v130, v130
    v_dot2c_f32_bf16 v178, s100, v131
    v_dot2c_f32_bf16 v179, v131, v131
    s_waitcnt lgkmcnt(5)
    v_dot2c_f32_bf16 v176, s100, v132
    v_dot2c_f32_bf16 v177, v132, v132
    v_dot2c_f32_bf16 v178, s100, v133
    v_dot2c_f32_bf16 v179, v133, v133
    s_waitcnt lgkmcnt(4)
    v_dot2c_f32_bf16 v176, s100, v134
    v_dot2c_f32_bf16 v177, v134, v134
    v_dot2c_f32_bf16 v178, s100, v135
    v_dot2c_f32_bf16 v179, v135, v135
    s_waitcnt lgkmcnt(3)
    v_dot2c_f32_bf16 v176, s100, v136
    v_dot2c_f32_bf16 v177, v136, v136
    v_dot2c_f32_bf16 v178, s100, v137
    v_dot2c_f32_bf16 v179, v137, v137
    s_waitcnt lgkmcnt(2)
    v_dot2c_f32_bf16 v176, s100, v138
    v_dot2c_f32_bf16 v177, v138, v138
    v_dot2c_f32_bf16 v178, s100, v139
    v_dot2c_f32_bf16 v179, v139, v139
    s_waitcnt lgkmcnt(1)
    v_dot2c_f32_bf16 v176, s100, v140
    v_dot2c_f32_bf16 v177, v140, v140
    v_dot2c_f32_bf16 v178, s100, v141
    v_dot2c_f32_bf16 v179, v141, v141
    s_waitcnt lgkmcnt(0)
    v_dot2c_f32_bf16 v176, s100, v142
    v_dot2c_f32_bf16 v177, v142, v142
    v_dot2c_f32_bf16 v178, s100, v143
    v_dot2c_f32_bf16 v179, v143, v143
    s_waitcnt vmcnt(0)
    s_barrier
    ds_read_b64_tr_b16 v[128:129], v6 offset:49152
    ds_read_b64_tr_b16 v[130:131], v6 offset:51200
    ds_read_b64_tr_b16 v[132:133], v6 offset:53248
    ds_read_b64_tr_b16 v[134:135], v6 offset:55296
    ds_read_b64_tr_b16 v[136:137], v6 offset:57344
    ds_read_b64_tr_b16 v[138:139], v6 offset:59392
    ds_read_b64_tr_b16 v[140:141], v6 offset:61440
    ds_read_b64_tr_b16 v[142:143], v6 offset:63488
    s_waitcnt lgkmcnt(7)
    v_dot2c_f32_bf16 v176, s100, v128
    v_dot2c_f32_bf16 v177, v128, v128
    v_dot2c_f32_bf16 v178, s100, v129
    v_dot2c_f32_bf16 v179, v129, v129
    s_waitcnt lgkmcnt(6)
    v_dot2c_f32_bf16 v176, s100, v130
    v_dot2c_f32_bf16 v177, v130, v130
    v_dot2c_f32_bf16 v178, s100, v131
    v_dot2c_f32_bf16 v179, v131, v131
    s_waitcnt lgkmcnt(5)
    v_dot2c_f32_bf16 v176, s100, v132
    v_dot2c_f32_bf16 v177, v132, v132
    v_dot2c_f32_bf16 v178, s100, v133
    v_dot2c_f32_bf16 v179, v133, v133
    s_waitcnt lgkmcnt(4)
    v_dot2c_f32_bf16 v176, s100, v134
    v_dot2c_f32_bf16 v177, v134, v134
    v_dot2c_f32_bf16 v178, s100, v135
    v_dot2c_f32_bf16 v179, v135, v135
    s_waitcnt lgkmcnt(3)
    v_dot2c_f32_bf16 v176, s100, v136
    v_dot2c_f32_bf16 v177, v136, v136
    v_dot2c_f32_bf16 v178, s100, v137
    v_dot2c_f32_bf16 v179, v137, v137
    s_waitcnt lgkmcnt(2)
    v_dot2c_f32_bf16 v176, s100, v138
    v_dot2c_f32_bf16 v177, v138, v138
    v_dot2c_f32_bf16 v178, s100, v139
    v_dot2c_f32_bf16 v179, v139, v139
    s_waitcnt lgkmcnt(1)
    v_dot2c_f32_bf16 v176, s100, v140
    v_dot2c_f32_bf16 v177, v140, v140
    v_dot2c_f32_bf16 v178, s100, v141
    v_dot2c_f32_bf16 v179, v141, v141
    s_waitcnt lgkmcnt(0)
    v_dot2c_f32_bf16 v176, s100, v142
    v_dot2c_f32_bf16 v177, v142, v142
    v_dot2c_f32_bf16 v178, s100, v143
    v_dot2c_f32_bf16 v179, v143, v143
    s_nop 1
    v_add_f32 v176, v176, v178
    v_add_f32 v177, v177, v179
    v_mov_b32 v180, v176
    v_mov_b32 v181, v177
    s_nop 0
    v_permlane32_swap_b32 v180, v176
    v_permlane32_swap_b32 v181, v177
    v_add_f32 v176, v176, v180
    v_add_f32 v177, v177, v181
    v_mov_b32 v180, v176
    v_mov_b32 v181, v177
    s_nop 0
    v_permlane16_swap_b32 v180, v176
    v_permlane16_swap_b32 v181, v177
    v_add_f32 v176, v176, v180
    v_add_f32 v177, v177, v181
    v_mov_b32 v178, v176
    v_mov_b32 v179, v177
    s_mov_b32 s60, 0x3b000000
    v_mul_f32 v176, s60, v176
    v_mul_f32 v177, s60, v177
    v_mul_f32 v178, s60, v178
    v_mul_f32 v179, s60, v179
    v_fma_f32 v177, -v176, v176, v177
    v_fma_f32 v179, -v178, v178, v179
    v_max_f32 v177, 0, v177
    v_max_f32 v179, 0, v179
    v_cvt_pk_bf16_f32 v180, v177, v179
    s_mov_b32 s60, 0x3727c5ac
    v_lshlrev_b32 v182, 16, v180
    v_and_b32 v183, 0xffff0000, v180
    v_add_f32 v182, s60, v182
    v_add_f32 v183, s60, v183
    v_cvt_pk_bf16_f32 v180, v182, v183
    v_lshlrev_b32 v182, 16, v180
    v_and_b32 v183, 0xffff0000, v180
    v_sqrt_f32 v182, v182
    v_sqrt_f32 v183, v183
    v_cvt_pk_bf16_f32 v180, v176, v182
    v_lshlrev_b32 v184, 16, v180
    v_and_b32 v185, 0xffff0000, v180
    v_mov_b32 v186, s6
    v_mov_b32 v187, s7
    s_movk_i32 s60, 16384
    s_mov_b64 exec, 0xffff
    buffer_store_dwordx4 v[184:187], v7, s[36:39], s60 offen sc1
    s_mov_b64 exec, -1
    ds_read_b64_tr_b16 a[224:225], v246 offset:0
    ds_read_b64_tr_b16 a[226:227], v246 offset:512
    ds_read_b64_tr_b16 a[228:229], v246 offset:2048
    ds_read_b64_tr_b16 a[230:231], v246 offset:2560
    ds_read_b64_tr_b16 a[232:233], v247 offset:0
    ds_read_b64_tr_b16 a[234:235], v247 offset:512
    ds_read_b64_tr_b16 a[236:237], v247 offset:2048
    ds_read_b64_tr_b16 a[238:239], v247 offset:2560
    ds_read_b64_tr_b16 a[240:241], v246 offset:4096
    ds_read_b64_tr_b16 a[242:243], v246 offset:4608
    ds_read_b64_tr_b16 a[244:245], v246 offset:6144
    ds_read_b64_tr_b16 a[246:247], v246 offset:6656
    ds_read_b64_tr_b16 a[248:249], v247 offset:4096
    ds_read_b64_tr_b16 a[250:251], v247 offset:4608
    ds_read_b64_tr_b16 a[252:253], v247 offset:6144
    ds_read_b64_tr_b16 a[254:255], v247 offset:6656
    ds_read_b64_tr_b16 v[208:209], v246 offset:8192
    ds_read_b64_tr_b16 v[210:211], v246 offset:8704
    ds_read_b64_tr_b16 v[212:213], v246 offset:10240
    ds_read_b64_tr_b16 v[214:215], v246 offset:10752
    ds_read_b64_tr_b16 v[216:217], v247 offset:8192
    ds_read_b64_tr_b16 v[218:219], v247 offset:8704
    ds_read_b64_tr_b16 v[220:221], v247 offset:10240
    ds_read_b64_tr_b16 v[222:223], v247 offset:10752
    ds_read_b64_tr_b16 v[224:225], v246 offset:12288
    ds_read_b64_tr_b16 v[226:227], v246 offset:12800
    ds_read_b64_tr_b16 v[228:229], v246 offset:14336
    ds_read_b64_tr_b16 v[230:231], v246 offset:14848
    ds_read_b64_tr_b16 v[232:233], v247 offset:12288
    ds_read_b64_tr_b16 v[234:235], v247 offset:12800
    ds_read_b64_tr_b16 v[236:237], v247 offset:14336
    ds_read_b64_tr_b16 v[238:239], v247 offset:14848
    s_waitcnt lgkmcnt(0)
    s_add_u32 m0, s57, 0
    s_mov_b32 s44, 196608
    buffer_load_dwordx4 v240, s[28:31], s44 offen offset:0 lds
    buffer_load_dwordx4 v241, s[28:31], s44 offen offset:1024 lds
    buffer_load_dwordx4 v242, s[28:31], s44 offen offset:2048 lds
    buffer_load_dwordx4 v243, s[28:31], s44 offen offset:3072 lds
    s_add_u32 m0, s57, 4096
    s_mov_b32 s44, 229376
    buffer_load_dwordx4 v240, s[28:31], s44 offen offset:0 lds
    buffer_load_dwordx4 v241, s[28:31], s44 offen offset:1024 lds
    buffer_load_dwordx4 v242, s[28:31], s44 offen offset:2048 lds
    buffer_load_dwordx4 v243, s[28:31], s44 offen offset:3072 lds
    s_add_u32 m0, s57, 8192
    s_mov_b32 s44, 262144
    buffer_load_dwordx4 v240, s[28:31], s44 offen offset:0 lds
    buffer_load_dwordx4 v241, s[28:31], s44 offen offset:1024 lds
    buffer_load_dwordx4 v242, s[28:31], s44 offen offset:2048 lds
    buffer_load_dwordx4 v243, s[28:31], s44 offen offset:3072 lds
    s_waitcnt lgkmcnt(0)
    s_barrier
    v_min_u32 v14, 31, v1
    v_lshl_add_u32 v14, v14, 2, s86
    v_lshl_add_u32 v15, v1, 4, s87
    v_and_b32 v12, 31, v1
    v_add_u32 v12, s89, v12
    v_lshrrev_b32 v13, 5, v1
    v_lshl_add_u32 v13, v13, 3, s90
    v_lshlrev_b32 v16, 12, v13
    v_lshl_add_u32 v16, v12, 1, v16
    v_add_u32 v16, 9437184, v16
    v_lshlrev_b32 v19, 10, v12
    v_lshl_add_u32 v19, v13, 1, v19
    v_add_u32 v23, 2818048, v15
    v_add_u32 v12, 16384, v16
    v_lshl_add_u32 v18, v1, 4, s91
    v_lshl_add_u32 v17, v1, 4, s92
    v_lshl_add_u32 v21, v1, 4, s93
    v_lshl_add_u32 v22, v1, 4, s94
    ds_read_b64_tr_b16 a[88:89], v244 offset:32768
    ds_read_b64_tr_b16 a[90:91], v244 offset:33280
    ds_read_b64_tr_b16 a[92:93], v244 offset:34816
    ds_read_b64_tr_b16 a[94:95], v244 offset:35328
    ds_read_b64_tr_b16 a[96:97], v245 offset:32768
    ds_read_b64_tr_b16 a[98:99], v245 offset:33280
    ds_read_b64_tr_b16 a[100:101], v245 offset:34816
    ds_read_b64_tr_b16 a[102:103], v245 offset:35328
    ds_read_b64_tr_b16 a[104:105], v244 offset:36864
    ds_read_b64_tr_b16 a[106:107], v244 offset:37376
    ds_read_b64_tr_b16 a[108:109], v244 offset:38912
    ds_read_b64_tr_b16 a[110:111], v244 offset:39424
    ds_read_b64_tr_b16 a[112:113], v245 offset:36864
    ds_read_b64_tr_b16 a[114:115], v245 offset:37376
    ds_read_b64_tr_b16 a[116:117], v245 offset:38912
    ds_read_b64_tr_b16 a[118:119], v245 offset:39424
    s_waitcnt vmcnt(8)
    ds_read_b64_tr_b16 a[120:121], v246 offset:0
    ds_read_b64_tr_b16 a[122:123], v246 offset:512
    ds_read_b64_tr_b16 a[124:125], v246 offset:2048
    ds_read_b64_tr_b16 a[126:127], v246 offset:2560
    ds_read_b64_tr_b16 a[128:129], v247 offset:0
    ds_read_b64_tr_b16 a[130:131], v247 offset:512
    ds_read_b64_tr_b16 a[132:133], v247 offset:2048
    ds_read_b64_tr_b16 a[134:135], v247 offset:2560
    s_waitcnt vmcnt(4)
    ds_read_b64_tr_b16 a[136:137], v246 offset:4096
    ds_read_b64_tr_b16 a[138:139], v246 offset:4608
    ds_read_b64_tr_b16 a[140:141], v246 offset:6144
    ds_read_b64_tr_b16 a[142:143], v246 offset:6656
    ds_read_b64_tr_b16 a[144:145], v247 offset:4096
    ds_read_b64_tr_b16 a[146:147], v247 offset:4608
    ds_read_b64_tr_b16 a[148:149], v247 offset:6144
    ds_read_b64_tr_b16 a[150:151], v247 offset:6656
    s_waitcnt vmcnt(0)
    ds_read_b64_tr_b16 a[152:153], v246 offset:8192
    ds_read_b64_tr_b16 a[154:155], v246 offset:8704
    ds_read_b64_tr_b16 a[156:157], v246 offset:10240
    ds_read_b64_tr_b16 a[158:159], v246 offset:10752
    ds_read_b64_tr_b16 a[160:161], v247 offset:8192
    ds_read_b64_tr_b16 a[162:163], v247 offset:8704
    ds_read_b64_tr_b16 a[164:165], v247 offset:10240
    ds_read_b64_tr_b16 a[166:167], v247 offset:10752
    buffer_load_dword v253, v14, s[36:39], 0 offen offset:0 sc1
    s_waitcnt vmcnt(0)
    v_cmp_ne_u32 vcc, s6, v253
    s_and_b32 vcc_lo, vcc_lo, s101
    s_mov_b32 vcc_hi, 0
    s_or_b64 vcc, vcc, vcc
    s_cbranch_vccnz L_f3_0s_retry
L_f3_0s_ok:
    buffer_load_dwordx4 a[0:3], v15, s[36:39], 0 offen offset:0 sc1
    buffer_load_dwordx4 a[4:7], v15, s[36:39], 0 offen offset:1024 sc1
    buffer_load_dwordx4 a[8:11], v15, s[36:39], 0 offen offset:2048 sc1
    buffer_load_dwordx4 a[12:15], v15, s[36:39], 0 offen offset:3072 sc1
    buffer_load_dwordx4 a[16:19], v15, s[36:39], s52 offen offset:0 sc1
    buffer_load_dwordx4 a[20:23], v15, s[36:39], s52 offen offset:1024 sc1
    buffer_load_dwordx4 a[24:27], v15, s[36:39], s52 offen offset:2048 sc1
    buffer_load_dwordx4 a[28:31], v15, s[36:39], s52 offen offset:3072 sc1
    buffer_load_dwordx4 a[32:35], v15, s[36:39], s88 offen offset:2048 sc1
    buffer_load_dwordx4 a[36:39], v15, s[36:39], s88 offen offset:3072 sc1
    s_cmp_eq_u32 s3, 3
    s_cbranch_scc1 L_s3_23
    buffer_load_dwordx4 a[40:43], v15, s[36:39], s95 offen offset:0 sc1
    buffer_load_dwordx4 a[44:47], v15, s[36:39], s95 offen offset:1024 sc1
L_s3_23:
    buffer_load_dwordx4 a[48:51], v15, s[36:39], s54 offen offset:0 sc1
    buffer_load_dwordx4 a[52:55], v15, s[36:39], s54 offen offset:1024 sc1
    buffer_load_dwordx4 a[56:59], v15, s[36:39], s54 offen offset:2048 sc1
    buffer_load_dwordx4 a[60:63], v15, s[36:39], s54 offen offset:3072 sc1
    buffer_load_dwordx4 a[64:67], v15, s[36:39], s53 offen offset:0 sc1
    buffer_load_dwordx4 a[68:71], v15, s[36:39], s53 offen offset:1024 sc1
    buffer_load_dwordx4 a[72:75], v15, s[36:39], s53 offen offset:2048 sc1
    buffer_load_dwordx4 a[76:79], v15, s[36:39], s53 offen offset:3072 sc1
    buffer_load_dwordx4 a[80:83], v15, s[36:39], s88 offen offset:0 sc1
    buffer_load_dwordx4 a[84:87], v15, s[36:39], s88 offen offset:1024 sc1
    s_waitcnt vmcnt(0) lgkmcnt(0)
    s_branch L_g2
L_u_retry:
    s_waitcnt vmcnt(0)
    buffer_load_dwordx4 v[68:71], v12, s[36:39], 0 offen offset:0 sc1
    buffer_load_dwordx4 v[72:75], v12, s[36:39], 0 offen offset:128 sc1
    buffer_load_dwordx4 v[76:79], v12, s[36:39], 0 offen offset:256 sc1
    buffer_load_dwordx4 v[80:83], v12, s[36:39], 0 offen offset:384 sc1
    buffer_load_dwordx4 v[84:87], v12, s[36:39], 0 offen offset:512 sc1
    buffer_load_dwordx4 v[88:91], v12, s[36:39], 0 offen offset:640 sc1
    s_waitcnt vmcnt(0)
    v_bitop3_b32 v92, v71, v75, s6 bitop3:0x7e
    v_bitop3_b32 v92, v92, v79, s6 bitop3:0xf6
    v_bitop3_b32 v92, v92, v83, s6 bitop3:0xf6
    v_bitop3_b32 v92, v92, v87, s6 bitop3:0xf6
    v_bitop3_b32 v92, v92, v91, s6 bitop3:0xf6
    v_cmp_ne_u32 vcc, 0, v92
    s_cbranch_vccz L_u_ok
    s_add_u32 s59, s59, 1
    s_and_b32 s60, s59, 63
    s_cmp_lg_u32 s60, 0
    s_cbranch_scc1 L_u_retry
    buffer_wbl2 sc1
    s_waitcnt vmcnt(0)
    s_cmp_lt_u32 s59, 32768
    s_cbranch_scc1 L_u_retry
    s_movk_i32 s60, 1
    s_branch L_timeout
L_st0_retry:
    s_waitcnt vmcnt(0)
    s_movk_i32 s51, 0
    buffer_load_dwordx4 a[208:211], v13, s[36:39], s51 offen offset:0 sc1
    buffer_load_dwordx4 a[212:215], v13, s[36:39], s51 offen offset:128 sc1
    buffer_load_dwordx4 a[216:219], v13, s[36:39], s51 offen offset:2048 sc1
    buffer_load_dwordx4 a[220:223], v13, s[36:39], s51 offen offset:2176 sc1
    s_waitcnt vmcnt(0)
    v_accvgpr_read_b32 v120, a211
    v_accvgpr_read_b32 v121, a215
    v_accvgpr_read_b32 v122, a219
    v_accvgpr_read_b32 v123, a223
    v_bitop3_b32 v126, v120, v121, s7 bitop3:0x7e
    v_bitop3_b32 v127, v122, v123, s7 bitop3:0x7e
    v_or_b32 v126, v126, v127
    v_cmp_lt_u32 vcc, 7, v126
    s_cbranch_vccz L_st0_ok
    s_add_u32 s59, s59, 1
    s_and_b32 s60, s59, 63
    s_cmp_lg_u32 s60, 0
    s_cbranch_scc1 L_st0_retry
    buffer_wbl2 sc1
    s_waitcnt vmcnt(0)
    s_cmp_lt_u32 s59, 32768
    s_cbranch_scc1 L_st0_retry
    s_movk_i32 s60, 9
    s_branch L_timeout
L_uhi_retry:
    s_waitcnt vmcnt(0)
    buffer_load_dwordx4 a[224:227], v7, s[36:39], 0 offen offset:0 sc1
    buffer_load_dwordx4 a[228:231], v7, s[36:39], 0 offen offset:128 sc1
    buffer_load_dwordx4 a[232:235], v7, s[36:39], 0 offen offset:256 sc1
    buffer_load_dwordx4 a[236:239], v7, s[36:39], 0 offen offset:384 sc1
    buffer_load_dwordx4 a[240:243], v7, s[36:39], 0 offen offset:512 sc1
    buffer_load_dwordx4 a[244:247], v7, s[36:39], 0 offen offset:640 sc1
    s_waitcnt vmcnt(0)
    v_accvgpr_read_b32 v120, a227
    v_accvgpr_read_b32 v121, a231
    v_accvgpr_read_b32 v122, a235
    v_accvgpr_read_b32 v123, a239
    v_accvgpr_read_b32 v124, a243
    v_accvgpr_read_b32 v125, a247
    v_bitop3_b32 v126, v120, v121, s6 bitop3:0x7e
    v_bitop3_b32 v126, v126, v122, s6 bitop3:0xf6
    v_bitop3_b32 v126, v126, v123, s6 bitop3:0xf6
    v_bitop3_b32 v126, v126, v124, s6 bitop3:0xf6
    v_bitop3_b32 v126, v126, v125, s6 bitop3:0xf6
    v_cmp_ne_u32 vcc, 0, v126
    s_cbranch_vccz L_uhi_ok
    s_add_u32 s59, s59, 1
    s_and_b32 s60, s59, 63
    s_cmp_lg_u32 s60, 0
    s_cbranch_scc1 L_uhi_retry
    buffer_wbl2 sc1
    s_waitcnt vmcnt(0)
    s_cmp_lt_u32 s59, 32768
    s_cbranch_scc1 L_uhi_retry
    s_movk_i32 s60, 1
    s_branch L_timeout
L_st1_retry:
    s_waitcnt vmcnt(0)
    s_movk_i32 s51, 8192
    buffer_load_dwordx4 a[208:211], v13, s[36:39], s51 offen offset:0 sc1
    buffer_load_dwordx4 a[212:215], v13, s[36:39], s51 offen offset:128 sc1
    buffer_load_dwordx4 a[216:219], v13, s[36:39], s51 offen offset:2048 sc1
    buffer_load_dwordx4 a[220:223], v13, s[36:39], s51 offen offset:2176 sc1
    s_waitcnt vmcnt(0)
    v_accvgpr_read_b32 v120, a211
    v_accvgpr_read_b32 v121, a215
    v_accvgpr_read_b32 v122, a219
    v_accvgpr_read_b32 v123, a223
    v_bitop3_b32 v126, v120, v121, s7 bitop3:0x7e
    v_bitop3_b32 v127, v122, v123, s7 bitop3:0x7e
    v_or_b32 v126, v126, v127
    v_cmp_lt_u32 vcc, 7, v126
    s_cbranch_vccz L_st1_ok
    s_add_u32 s59, s59, 1
    s_and_b32 s60, s59, 63
    s_cmp_lg_u32 s60, 0
    s_cbranch_scc1 L_st1_retry
    buffer_wbl2 sc1
    s_waitcnt vmcnt(0)
    s_cmp_lt_u32 s59, 32768
    s_cbranch_scc1 L_st1_retry
    s_movk_i32 s60, 10
    s_branch L_timeout
L_cnt0_retry:
    s_waitcnt vmcnt(0)
    s_movk_i32 s51, 0
    buffer_load_dword v253, v252, s[36:39], s51 offen sc1
    s_waitcnt vmcnt(0)
    v_cmp_ne_u32 vcc, 16, v253
    s_cbranch_vccz L_cnt0_ok
    s_add_u32 s59, s59, 1
    s_and_b32 s60, s59, 63
    s_cmp_lg_u32 s60, 0
    s_cbranch_scc1 L_cnt0_retry
    buffer_wbl2 sc1
    s_waitcnt vmcnt(0)
    s_cmp_lt_u32 s59, 32768
    s_cbranch_scc1 L_cnt0_retry
    s_movk_i32 s60, 3
    s_branch L_timeout
L_cnt1_retry:
    s_waitcnt vmcnt(0)
    s_movk_i32 s51, 16384
    buffer_load_dword v253, v252, s[36:39], s51 offen sc1
    s_waitcnt vmcnt(0)
    v_cmp_ne_u32 vcc, 16, v253
    s_cbranch_vccz L_cnt1_ok
    s_add_u32 s59, s59, 1
    s_and_b32 s60, s59, 63
    s_cmp_lg_u32 s60, 0
    s_cbranch_scc1 L_cnt1_retry
    buffer_wbl2 sc1
    s_waitcnt vmcnt(0)
    s_cmp_lt_u32 s59, 32768
    s_cbranch_scc1 L_cnt1_retry
    s_movk_i32 s60, 4
    s_branch L_timeout
L_st2_0_retry:
    s_waitcnt vmcnt(0)
    s_movk_i32 s51, 0
    buffer_load_dwordx4 v[176:179], v251, s[36:39], s51 offen offset:0 sc1
    buffer_load_dwordx4 v[180:183], v251, s[36:39], s51 offen offset:256 sc1
    buffer_load_dwordx4 v[184:187], v251, s[36:39], s51 offen offset:512 sc1
    buffer_load_dwordx4 v[188:191], v251, s[36:39], s51 offen offset:768 sc1
    s_waitcnt vmcnt(0)
    v_bitop3_b32 v172, v178, v182, s6 bitop3:0x7e
    v_bitop3_b32 v173, v179, v183, s7 bitop3:0x7e
    v_bitop3_b32 v174, v186, v190, s6 bitop3:0x7e
    v_bitop3_b32 v175, v187, v191, s7 bitop3:0x7e
    v_or3_b32 v254, v172, v173, v174
    v_or_b32 v254, v254, v175
    v_cmp_ne_u32 vcc, 0, v254
    s_cbranch_vccz L_st2_0_ok
    s_add_u32 s59, s59, 1
    s_and_b32 s60, s59, 63
    s_cmp_lg_u32 s60, 0
    s_cbranch_scc1 L_st2_0_retry
    buffer_wbl2 sc1
    s_waitcnt vmcnt(0)
    s_cmp_lt_u32 s59, 32768
    s_cbranch_scc1 L_st2_0_retry
    s_movk_i32 s60, 7
    s_branch L_timeout
L_f3_0_retry:
    s_waitcnt vmcnt(0)
    buffer_load_dword v253, v14, s[36:39], 0 offen offset:0 sc1
    s_waitcnt vmcnt(0)
    v_cmp_ne_u32 vcc, s6, v253
    s_and_b32 vcc_lo, vcc_lo, s101
    s_mov_b32 vcc_hi, 0
    s_or_b64 vcc, vcc, vcc
    s_cbranch_vccz L_f3_0_ok
    s_add_u32 s59, s59, 1
    s_and_b32 s60, s59, 63
    s_cmp_lg_u32 s60, 0
    s_cbranch_scc1 L_f3_0_retry
    buffer_wbl2 sc1
    s_waitcnt vmcnt(0)
    s_cmp_lt_u32 s59, 32768
    s_cbranch_scc1 L_f3_0_retry
    s_movk_i32 s60, 5
    s_branch L_timeout
L_st2_1_retry:
    s_waitcnt vmcnt(0)
    s_movk_i32 s51, 16384
    buffer_load_dwordx4 v[176:179], v251, s[36:39], s51 offen offset:0 sc1
    buffer_load_dwordx4 v[180:183], v251, s[36:39], s51 offen offset:256 sc1
    buffer_load_dwordx4 v[184:187], v251, s[36:39], s51 offen offset:512 sc1
    buffer_load_dwordx4 v[188:191], v251, s[36:39], s51 offen offset:768 sc1
    s_waitcnt vmcnt(0)
    v_bitop3_b32 v172, v178, v182, s6 bitop3:0x7e
    v_bitop3_b32 v173, v179, v183, s7 bitop3:0x7e
    v_bitop3_b32 v174, v186, v190, s6 bitop3:0x7e
    v_bitop3_b32 v175, v187, v191, s7 bitop3:0x7e
    v_or3_b32 v254, v172, v173, v174
    v_or_b32 v254, v254, v175
    v_cmp_ne_u32 vcc, 0, v254
    s_cbranch_vccz L_st2_1_ok
    s_add_u32 s59, s59, 1
    s_and_b32 s60, s59, 63
    s_cmp_lg_u32 s60, 0
    s_cbranch_scc1 L_st2_1_retry
    buffer_wbl2 sc1
    s_waitcnt vmcnt(0)
    s_cmp_lt_u32 s59, 32768
    s_cbranch_scc1 L_st2_1_retry
    s_movk_i32 s60, 8
    s_branch L_timeout
L_f3_1_retry:
    s_waitcnt vmcnt(0)
    buffer_load_dword v253, v14, s[36:39], 0 offen offset:1024 sc1
    s_waitcnt vmcnt(0)
    v_cmp_ne_u32 vcc, s6, v253
    s_and_b32 vcc_lo, vcc_lo, s101
    s_mov_b32 vcc_hi, 0
    s_or_b64 vcc, vcc, vcc
    s_cbranch_vccz L_f3_1_ok
    s_add_u32 s59, s59, 1
    s_and_b32 s60, s59, 63
    s_cmp_lg_u32 s60, 0
    s_cbranch_scc1 L_f3_1_retry
    buffer_wbl2 sc1
    s_waitcnt vmcnt(0)
    s_cmp_lt_u32 s59, 32768
    s_cbranch_scc1 L_f3_1_retry
    s_movk_i32 s60, 6
    s_branch L_timeout
L_cnt0s_retry:
    s_waitcnt vmcnt(0)
    s_movk_i32 s51, 0
    buffer_load_dword v253, v252, s[36:39], s51 offen sc1
    s_waitcnt vmcnt(0)
    v_cmp_ne_u32 vcc, 16, v253
    s_cbranch_vccz L_cnt0s_ok
    s_add_u32 s59, s59, 1
    s_and_b32 s60, s59, 63
    s_cmp_lg_u32 s60, 0
    s_cbranch_scc1 L_cnt0s_retry
    buffer_wbl2 sc1
    s_waitcnt vmcnt(0)
    s_cmp_lt_u32 s59, 32768
    s_cbranch_scc1 L_cnt0s_retry
    s_movk_i32 s60, 3
    s_branch L_timeout
L_cnt1s_retry:
    s_waitcnt vmcnt(0)
    s_movk_i32 s51, 16384
    buffer_load_dword v253, v252, s[36:39], s51 offen sc1
    s_waitcnt vmcnt(0)
    v_cmp_ne_u32 vcc, 16, v253
    s_cbranch_vccz L_cnt1s_ok
    s_add_u32 s59, s59, 1
    s_and_b32 s60, s59, 63
    s_cmp_lg_u32 s60, 0
    s_cbranch_scc1 L_cnt1s_retry
    buffer_wbl2 sc1
    s_waitcnt vmcnt(0)
    s_cmp_lt_u32 s59, 32768
    s_cbranch_scc1 L_cnt1s_retry
    s_movk_i32 s60, 4
    s_branch L_timeout
L_f3_0s_retry:
    s_waitcnt vmcnt(0)
    buffer_load_dword v253, v14, s[36:39], 0 offen offset:0 sc1
    s_waitcnt vmcnt(0)
    v_cmp_ne_u32 vcc, s6, v253
    s_and_b32 vcc_lo, vcc_lo, s101
    s_mov_b32 vcc_hi, 0
    s_or_b64 vcc, vcc, vcc
    s_cbranch_vccz L_f3_0s_ok
    s_add_u32 s59, s59, 1
    s_and_b32 s60, s59, 63
    s_cmp_lg_u32 s60, 0
    s_cbranch_scc1 L_f3_0s_retry
    buffer_wbl2 sc1
    s_waitcnt vmcnt(0)
    s_cmp_lt_u32 s59, 32768
    s_cbranch_scc1 L_f3_0s_retry
    s_movk_i32 s60, 5
    s_branch L_timeout
L_timeout:
    s_load_dwordx2 s[44:45], s[0:1], 88
    s_mov_b32 s46, 256
    s_mov_b32 s47, 0x20000
    s_mov_b64 exec, 1
    v_mov_b32 v4, s60
    s_lshl_b32 s60, s60, 2
    v_mov_b32 v5, s60
    s_waitcnt lgkmcnt(0)
    buffer_store_dword v4, v5, s[44:47], 0 offen
    s_endpgm
L_code_end:
.section .rodata,"a"
.p2align 6
.amdhsa_kernel sequential_preLN__ssm_conv_h3__glu_gated_glu__prompt_kernel
  .amdhsa_next_free_vgpr 512
  .amdhsa_next_free_sgpr 102
  .amdhsa_accum_offset 256
  .amdhsa_group_segment_fixed_size 0
  .amdhsa_kernarg_size 104
  .amdhsa_user_sgpr_count 2
  .amdhsa_user_sgpr_kernarg_segment_ptr 1
  .amdhsa_system_sgpr_workgroup_id_x 1
  .amdhsa_float_denorm_mode_32 3
.end_amdhsa_kernel
```
